```python
import torch

def _softmax(x, axis=-1):
    return torch.softmax(x, dim=axis)
def _gelu(x):
    return torch.nn.functional.gelu(x, approximate="tanh")
def _silu(x):
    return torch.nn.functional.silu(x)
def _sigmoid(x):
    return torch.sigmoid(x)
def _layernorm(x, axis=-1, eps=1e-5):
    m = x.mean(dim=axis, keepdim=True)
    v = x.var(dim=axis, keepdim=True, unbiased=False)
    return (x - m) / torch.sqrt(v + eps)
def _scatter_add(tgt, idx, src, axis=0):
    return tgt.clone().index_add_(axis, idx, src)
def _segment_sum(src, seg, n):
    out = torch.zeros((n,) + src.shape[1:], dtype=src.dtype)
    return out.index_add_(0, seg, src)
def _pad(x, pw):
    flat = tuple(v for pair in reversed(pw) for v in pair)
    return torch.nn.functional.pad(x, flat)

kernel_name = 'standalone__ragged_sequences_packed_sequences__ragged'

def setup_inputs():

    _w = (lambda a: (lambda t: t.to(torch.bfloat16) if t.is_floating_point() else t)(torch.as_tensor(a)))
    cu = torch.tensor([0, 369, 582, 865, 1200], dtype=torch.int64)
    T = int(cu[-1])
    H, D = 16, 128
    lens = torch.diff(cu)
    seg_ids = torch.repeat_interleave(torch.arange(len(lens), dtype=torch.int64), lens)
    return {
        "q": _w((lambda *s: torch.randn(*s, dtype=torch.bfloat16) * 0.8)(T, H, D)),
        "k": _w((lambda *s: torch.randn(*s, dtype=torch.bfloat16) * 0.8)(T, H, D)),
        "v": _w((lambda *s: torch.randn(*s, dtype=torch.bfloat16) * 0.05)(T, H, D)),
        "seg_ids": _w(seg_ids),
    }

def reference(q, k, v, seg_ids):
    T, H, D = q.shape
    scale = D ** -0.5
    same_seq = seg_ids[:, None] == seg_ids[None, :]
    logits = torch.einsum("qhd,khd->hqk", q, k) * scale
    bias = (1.0 - (lambda x, dt: x.to(dt))(same_seq, q.dtype)) * (-1e9)
    p = _softmax(logits + bias[None, :, :], axis=-1)
    return torch.einsum("hqk,khd->qhd", p, v)
```

```asm
; @launch grid=(256,1,1) block=(512,1,1) lds=150528
.amdgcn_target "amdgcn-amd-amdhsa--gfx950"
.text
.globl standalone__ragged_sequences_packed_sequences__ragged_kernel
.p2align 12
.type standalone__ragged_sequences_packed_sequences__ragged_kernel,@function
standalone__ragged_sequences_packed_sequences__ragged_kernel:
s_cmp_ge_u32 s2, 256
s_cbranch_scc1 L_end
s_load_dwordx4 s[4:7], s[0:1], 0
s_load_dwordx2 s[8:9], s[0:1], 16
s_load_dwordx2 s[10:11], s[0:1], 32
v_lshrrev_b32 v1, 6, v0
v_and_b32 v0, 63, v0
v_readfirstlane_b32 s14, v1
s_and_b32 s15, s2, 7
s_lshr_b32 s16, s2, 3
s_and_b32 s17, s16, 1
s_lshr_b32 s16, s16, 1
s_lshl_b32 s15, s15, 1
s_add_u32 s17, s17, s15
v_lshrrev_b32 v1, 2, v0
v_and_b32 v1, 3, v1
v_lshlrev_b32 v1, 12, v1
v_lshrrev_b32 v2, 4, v0
v_lshlrev_b32 v2, 6, v2
v_and_b32 v4, 3, v0
v_lshlrev_b32 v4, 4, v4
v_add3_u32 v3, v1, v2, v4
v_add_u32 v221, 15344, v3
v_add_u32 v222, 30688, v3
v_add_u32 v223, 46032, v3
s_and_b32 s3, s14, 3
s_and_b32 s29, s3, 1
s_cmp_eq_u32 s3, 3
s_cselect_b32 s24, 1, 0
s_cmp_eq_u32 s16, 2
s_cselect_b32 s29, s24, s29
s_lshr_b32 s24, s3, 1
s_cmp_ge_u32 s14, 4
s_cselect_b32 s29, s24, s29
s_cmp_lt_u32 s16, 10
s_cselect_b32 s18, 0, 865
s_mov_b32 s19, 335
s_cselect_b32 s19, 369, s19
s_mov_b32 s22, 1
s_cmp_lt_u32 s16, 4
s_cselect_b32 s18, 369, s18
s_cselect_b32 s19, 213, s19
s_cselect_b32 s22, 0, s22
s_sub_u32 s24, s16, s29
s_cmp_lt_i32 s24, 2
s_cselect_b32 s18, 582, s18
s_cselect_b32 s19, 283, s19
s_cselect_b32 s22, 4, s22
s_lshl_b32 s24, s17, 8
s_lshl_b32 s25, s18, 12
s_add_u32 s25, s25, s24
s_sub_u32 s27, s19, 1
s_lshl_b32 s26, s27, 12
s_add_u32 s26, s26, 256
s_lshr_b32 s27, s27, 5
s_cmp_lt_u32 s14, 4
s_cbranch_scc1 L_compute
v_add_u32 v225, 15360, v3
v_add_u32 v226, 30720, v3
v_add_u32 v227, 46080, v3
s_mov_b32 s38, s26
s_mov_b32 s39, 0x00020000
s_mov_b32 s42, s26
s_mov_b32 s43, 0x00020000
s_lshl_b32 s28, s27, 17
s_mov_b32 s55, 0
s_cmp_ge_u32 s16, 4
s_cbranch_scc1 L_ld_S
s_cmp_eq_u32 s16, 2
s_cbranch_scc1 L_ld_M
s_lshl_b32 s24, s3, 15
s_add_u32 s28, s28, s24
s_add_u32 s55, s55, s24
s_mul_i32 s48, s3, 2080
s_lshl_b32 s52, s3, 11
s_cmp_eq_u32 s16, 3
s_cbranch_scc1 L_ld_B7
s_mov_b32 s56, s55
s_waitcnt lgkmcnt(0)
s_add_u32 s36, s6, s25
s_addc_u32 s37, s7, 0
s_add_u32 m0, s48, 24960
s_nop 0
buffer_load_dwordx4 v3, s[36:39], s28 offen lds
buffer_load_dwordx4 v221, s[36:39], s28 offen offset:1040 lds
s_add_u32 s40, s8, s25
s_addc_u32 s41, s9, 0
s_add_u32 m0, s48, 41600
s_nop 0
buffer_load_dwordx4 v3, s[36:39], s55 offen lds
buffer_load_dwordx4 v221, s[36:39], s55 offen offset:1040 lds
s_add_u32 s55, s55, 131072
s_add_u32 m0, s52, 108544
s_nop 0
buffer_load_dwordx4 v3, s[40:43], s28 offen lds
buffer_load_dwordx4 v225, s[40:43], s28 offen offset:1024 lds
s_add_u32 m0, s48, 58240
s_nop 0
buffer_load_dwordx4 v3, s[36:39], s55 offen lds
buffer_load_dwordx4 v221, s[36:39], s55 offen offset:1040 lds
s_add_u32 s55, s55, 131072
s_add_u32 m0, s52, 124928
s_nop 0
buffer_load_dwordx4 v3, s[40:43], s56 offen lds
buffer_load_dwordx4 v225, s[40:43], s56 offen offset:1024 lds
s_add_u32 s56, s56, 131072
s_waitcnt vmcnt(8)
s_barrier
s_waitcnt vmcnt(6)
s_barrier
s_add_u32 m0, s48, 16640
s_nop 0
buffer_load_dwordx4 v3, s[36:39], s55 offen lds
buffer_load_dwordx4 v221, s[36:39], s55 offen offset:1040 lds
s_add_u32 s55, s55, 131072
s_add_u32 m0, s52, 83968
s_nop 0
buffer_load_dwordx4 v3, s[40:43], s56 offen lds
buffer_load_dwordx4 v225, s[40:43], s56 offen offset:1024 lds
s_add_u32 s56, s56, 131072
s_waitcnt vmcnt(8)
s_barrier
s_add_u32 m0, s48, 33280
s_nop 0
buffer_load_dwordx4 v3, s[36:39], s55 offen lds
buffer_load_dwordx4 v221, s[36:39], s55 offen offset:1040 lds
s_add_u32 s55, s55, 131072
s_add_u32 m0, s52, 100352
s_nop 0
buffer_load_dwordx4 v3, s[40:43], s56 offen lds
buffer_load_dwordx4 v225, s[40:43], s56 offen offset:1024 lds
s_add_u32 s56, s56, 131072
s_waitcnt vmcnt(8)
s_barrier
s_add_u32 m0, s48, 49920
s_nop 0
buffer_load_dwordx4 v3, s[36:39], s55 offen lds
buffer_load_dwordx4 v221, s[36:39], s55 offen offset:1040 lds
s_add_u32 s55, s55, 131072
s_add_u32 m0, s52, 116736
s_nop 0
buffer_load_dwordx4 v3, s[40:43], s56 offen lds
buffer_load_dwordx4 v225, s[40:43], s56 offen offset:1024 lds
s_add_u32 s56, s56, 131072
s_add_u32 m0, s48, 24960
s_nop 0
buffer_load_dwordx4 v3, s[36:39], s55 offen lds
buffer_load_dwordx4 v221, s[36:39], s55 offen offset:1040 lds
s_add_u32 s55, s55, 131072
s_add_u32 m0, s52, 92160
s_nop 0
buffer_load_dwordx4 v3, s[40:43], s56 offen lds
buffer_load_dwordx4 v225, s[40:43], s56 offen offset:1024 lds
s_add_u32 s56, s56, 131072
s_waitcnt vmcnt(12)
s_barrier
s_add_u32 m0, s48, 41600
s_nop 0
buffer_load_dwordx4 v3, s[36:39], s55 offen lds
buffer_load_dwordx4 v221, s[36:39], s55 offen offset:1040 lds
s_add_u32 s55, s55, 131072
s_add_u32 m0, s52, 108544
s_nop 0
buffer_load_dwordx4 v3, s[40:43], s56 offen lds
buffer_load_dwordx4 v225, s[40:43], s56 offen offset:1024 lds
s_add_u32 s56, s56, 131072
s_waitcnt vmcnt(12)
s_barrier
s_add_u32 m0, s48, 58240
s_nop 0
buffer_load_dwordx4 v3, s[36:39], s55 offen lds
buffer_load_dwordx4 v221, s[36:39], s55 offen offset:1040 lds
s_add_u32 s55, s55, 131072
s_add_u32 m0, s52, 124928
s_nop 0
buffer_load_dwordx4 v3, s[40:43], s56 offen lds
buffer_load_dwordx4 v225, s[40:43], s56 offen offset:1024 lds
s_add_u32 s56, s56, 131072
s_waitcnt vmcnt(12)
s_barrier
s_add_u32 m0, s52, 83968
s_nop 0
buffer_load_dwordx4 v3, s[40:43], s56 offen lds
buffer_load_dwordx4 v225, s[40:43], s56 offen offset:1024 lds
s_add_u32 s56, s56, 131072
s_waitcnt vmcnt(10)
s_barrier
s_waitcnt vmcnt(6)
s_barrier
s_waitcnt vmcnt(2)
s_barrier
s_waitcnt vmcnt(0)
s_barrier
s_endpgm
L_ld_B7:
s_mov_b32 s56, s55
s_waitcnt lgkmcnt(0)
s_add_u32 s36, s6, s25
s_addc_u32 s37, s7, 0
s_add_u32 m0, s48, 58240
s_nop 0
buffer_load_dwordx4 v3, s[36:39], s28 offen lds
buffer_load_dwordx4 v221, s[36:39], s28 offen offset:1040 lds
s_add_u32 s40, s8, s25
s_addc_u32 s41, s9, 0
s_add_u32 m0, s48, 16640
s_nop 0
buffer_load_dwordx4 v3, s[36:39], s55 offen lds
buffer_load_dwordx4 v221, s[36:39], s55 offen offset:1040 lds
s_add_u32 s55, s55, 131072
s_add_u32 m0, s52, 83968
s_nop 0
buffer_load_dwordx4 v3, s[40:43], s28 offen lds
buffer_load_dwordx4 v225, s[40:43], s28 offen offset:1024 lds
s_add_u32 m0, s48, 33280
s_nop 0
buffer_load_dwordx4 v3, s[36:39], s55 offen lds
buffer_load_dwordx4 v221, s[36:39], s55 offen offset:1040 lds
s_add_u32 s55, s55, 131072
s_add_u32 m0, s52, 100352
s_nop 0
buffer_load_dwordx4 v3, s[40:43], s56 offen lds
buffer_load_dwordx4 v225, s[40:43], s56 offen offset:1024 lds
s_add_u32 s56, s56, 131072
s_waitcnt vmcnt(8)
s_barrier
s_waitcnt vmcnt(6)
s_barrier
s_add_u32 m0, s48, 49920
s_nop 0
buffer_load_dwordx4 v3, s[36:39], s55 offen lds
buffer_load_dwordx4 v221, s[36:39], s55 offen offset:1040 lds
s_add_u32 s55, s55, 131072
s_add_u32 m0, s52, 116736
s_nop 0
buffer_load_dwordx4 v3, s[40:43], s56 offen lds
buffer_load_dwordx4 v225, s[40:43], s56 offen offset:1024 lds
s_add_u32 s56, s56, 131072
s_waitcnt vmcnt(8)
s_barrier
s_add_u32 m0, s48, 24960
s_nop 0
buffer_load_dwordx4 v3, s[36:39], s55 offen lds
buffer_load_dwordx4 v221, s[36:39], s55 offen offset:1040 lds
s_add_u32 s55, s55, 131072
s_add_u32 m0, s52, 92160
s_nop 0
buffer_load_dwordx4 v3, s[40:43], s56 offen lds
buffer_load_dwordx4 v225, s[40:43], s56 offen offset:1024 lds
s_add_u32 s56, s56, 131072
s_waitcnt vmcnt(8)
s_barrier
s_add_u32 m0, s48, 41600
s_nop 0
buffer_load_dwordx4 v3, s[36:39], s55 offen lds
buffer_load_dwordx4 v221, s[36:39], s55 offen offset:1040 lds
s_add_u32 s55, s55, 131072
s_add_u32 m0, s52, 108544
s_nop 0
buffer_load_dwordx4 v3, s[40:43], s56 offen lds
buffer_load_dwordx4 v225, s[40:43], s56 offen offset:1024 lds
s_add_u32 s56, s56, 131072
s_add_u32 m0, s48, 58240
s_nop 0
buffer_load_dwordx4 v3, s[36:39], s55 offen lds
buffer_load_dwordx4 v221, s[36:39], s55 offen offset:1040 lds
s_add_u32 s55, s55, 131072
s_add_u32 m0, s52, 124928
s_nop 0
buffer_load_dwordx4 v3, s[40:43], s56 offen lds
buffer_load_dwordx4 v225, s[40:43], s56 offen offset:1024 lds
s_add_u32 s56, s56, 131072
s_waitcnt vmcnt(12)
s_barrier
s_add_u32 m0, s52, 83968
s_nop 0
buffer_load_dwordx4 v3, s[40:43], s56 offen lds
buffer_load_dwordx4 v225, s[40:43], s56 offen offset:1024 lds
s_add_u32 s56, s56, 131072
s_waitcnt vmcnt(10)
s_barrier
s_waitcnt vmcnt(6)
s_barrier
s_waitcnt vmcnt(2)
s_barrier
s_waitcnt vmcnt(0)
s_barrier
s_endpgm
L_ld_S:
s_cmp_eq_u32 s29, 0
s_cselect_b32 s28, s28, 1310720
s_cselect_b32 s55, 131072, 0
s_and_b32 s24, s3, 1
s_mul_i32 s48, s24, 4160
s_mul_i32 s30, s29, 8320
s_add_u32 s48, s48, s30
s_lshl_b32 s52, s24, 12
s_lshl_b32 s30, s29, 13
s_add_u32 s52, s52, s30
s_lshl_b32 s24, s24, 16
s_add_u32 s28, s28, s24
s_add_u32 s55, s55, s24
s_mov_b32 s56, s55
s_waitcnt lgkmcnt(0)
s_add_u32 s36, s6, s25
s_addc_u32 s37, s7, 0
s_add_u32 m0, s48, 16640
s_nop 0
buffer_load_dwordx4 v3, s[36:39], s28 offen lds
buffer_load_dwordx4 v221, s[36:39], s28 offen offset:1040 lds
buffer_load_dwordx4 v222, s[36:39], s28 offen offset:2080 lds
buffer_load_dwordx4 v223, s[36:39], s28 offen offset:3120 lds
s_add_u32 s40, s8, s25
s_addc_u32 s41, s9, 0
s_add_u32 m0, s48, 33280
s_nop 0
buffer_load_dwordx4 v3, s[36:39], s55 offen lds
buffer_load_dwordx4 v221, s[36:39], s55 offen offset:1040 lds
buffer_load_dwordx4 v222, s[36:39], s55 offen offset:2080 lds
buffer_load_dwordx4 v223, s[36:39], s55 offen offset:3120 lds
s_add_u32 s55, s55, 262144
s_add_u32 m0, s52, 100352
s_nop 0
buffer_load_dwordx4 v3, s[40:43], s28 offen lds
buffer_load_dwordx4 v225, s[40:43], s28 offen offset:1024 lds
buffer_load_dwordx4 v226, s[40:43], s28 offen offset:2048 lds
buffer_load_dwordx4 v227, s[40:43], s28 offen offset:3072 lds
s_waitcnt vmcnt(8)
s_barrier
s_add_u32 m0, s48, 49920
s_nop 0
buffer_load_dwordx4 v3, s[36:39], s55 offen lds
buffer_load_dwordx4 v221, s[36:39], s55 offen offset:1040 lds
buffer_load_dwordx4 v222, s[36:39], s55 offen offset:2080 lds
buffer_load_dwordx4 v223, s[36:39], s55 offen offset:3120 lds
s_add_u32 s55, s55, 262144
s_add_u32 m0, s52, 116736
s_nop 0
buffer_load_dwordx4 v3, s[40:43], s56 offen lds
buffer_load_dwordx4 v225, s[40:43], s56 offen offset:1024 lds
buffer_load_dwordx4 v226, s[40:43], s56 offen offset:2048 lds
buffer_load_dwordx4 v227, s[40:43], s56 offen offset:3072 lds
s_add_u32 s56, s56, 262144
s_barrier
s_waitcnt vmcnt(12)
s_barrier
s_add_u32 m0, s48, 0
s_nop 0
buffer_load_dwordx4 v3, s[36:39], s55 offen lds
buffer_load_dwordx4 v221, s[36:39], s55 offen offset:1040 lds
buffer_load_dwordx4 v222, s[36:39], s55 offen offset:2080 lds
buffer_load_dwordx4 v223, s[36:39], s55 offen offset:3120 lds
s_add_u32 s55, s55, 262144
s_waitcnt vmcnt(12)
s_barrier
s_add_u32 m0, s52, 67584
s_nop 0
buffer_load_dwordx4 v3, s[40:43], s56 offen lds
buffer_load_dwordx4 v225, s[40:43], s56 offen offset:1024 lds
buffer_load_dwordx4 v226, s[40:43], s56 offen offset:2048 lds
buffer_load_dwordx4 v227, s[40:43], s56 offen offset:3072 lds
s_add_u32 s56, s56, 262144
s_waitcnt vmcnt(8)
s_barrier
s_add_u32 m0, s48, 16640
s_nop 0
buffer_load_dwordx4 v3, s[36:39], s55 offen lds
buffer_load_dwordx4 v221, s[36:39], s55 offen offset:1040 lds
buffer_load_dwordx4 v222, s[36:39], s55 offen offset:2080 lds
buffer_load_dwordx4 v223, s[36:39], s55 offen offset:3120 lds
s_add_u32 s55, s55, 262144
s_add_u32 m0, s52, 83968
s_nop 0
buffer_load_dwordx4 v3, s[40:43], s56 offen lds
buffer_load_dwordx4 v225, s[40:43], s56 offen offset:1024 lds
buffer_load_dwordx4 v226, s[40:43], s56 offen offset:2048 lds
buffer_load_dwordx4 v227, s[40:43], s56 offen offset:3072 lds
s_add_u32 s56, s56, 262144
s_waitcnt vmcnt(8)
s_barrier
s_add_u32 m0, s48, 33280
s_nop 0
buffer_load_dwordx4 v3, s[36:39], s55 offen lds
buffer_load_dwordx4 v221, s[36:39], s55 offen offset:1040 lds
buffer_load_dwordx4 v222, s[36:39], s55 offen offset:2080 lds
buffer_load_dwordx4 v223, s[36:39], s55 offen offset:3120 lds
s_add_u32 s55, s55, 262144
s_add_u32 m0, s52, 100352
s_nop 0
buffer_load_dwordx4 v3, s[40:43], s56 offen lds
buffer_load_dwordx4 v225, s[40:43], s56 offen offset:1024 lds
buffer_load_dwordx4 v226, s[40:43], s56 offen offset:2048 lds
buffer_load_dwordx4 v227, s[40:43], s56 offen offset:3072 lds
s_add_u32 s56, s56, 262144
s_waitcnt vmcnt(8)
s_barrier
s_add_u32 m0, s52, 116736
s_nop 0
buffer_load_dwordx4 v3, s[40:43], s56 offen lds
buffer_load_dwordx4 v225, s[40:43], s56 offen offset:1024 lds
buffer_load_dwordx4 v226, s[40:43], s56 offen offset:2048 lds
buffer_load_dwordx4 v227, s[40:43], s56 offen offset:3072 lds
s_add_u32 s56, s56, 262144
s_waitcnt vmcnt(4)
s_barrier
s_waitcnt vmcnt(0)
s_barrier
s_endpgm
L_ld_M:
s_and_b32 s24, s3, 1
s_mul_i32 s48, s24, 4160
s_mul_i32 s30, s29, 8320
s_add_u32 s48, s48, s30
s_lshl_b32 s52, s24, 12
s_lshl_b32 s30, s29, 13
s_add_u32 s52, s52, s30
s_lshl_b32 s24, s24, 16
s_add_u32 s28, s28, s24
s_add_u32 s55, s55, s24
s_cmp_eq_u32 s29, 0
s_cbranch_scc1 L_ld_M7
s_mov_b32 s56, s55
s_waitcnt lgkmcnt(0)
s_add_u32 s36, s6, s25
s_addc_u32 s37, s7, 0
s_add_u32 m0, s48, 16640
s_nop 0
buffer_load_dwordx4 v3, s[36:39], s28 offen lds
buffer_load_dwordx4 v221, s[36:39], s28 offen offset:1040 lds
buffer_load_dwordx4 v222, s[36:39], s28 offen offset:2080 lds
buffer_load_dwordx4 v223, s[36:39], s28 offen offset:3120 lds
s_add_u32 s40, s8, s25
s_addc_u32 s41, s9, 0
s_add_u32 m0, s48, 33280
s_nop 0
buffer_load_dwordx4 v3, s[36:39], s55 offen lds
buffer_load_dwordx4 v221, s[36:39], s55 offen offset:1040 lds
buffer_load_dwordx4 v222, s[36:39], s55 offen offset:2080 lds
buffer_load_dwordx4 v223, s[36:39], s55 offen offset:3120 lds
s_add_u32 s55, s55, 131072
s_add_u32 m0, s52, 100352
s_nop 0
buffer_load_dwordx4 v3, s[40:43], s28 offen lds
buffer_load_dwordx4 v225, s[40:43], s28 offen offset:1024 lds
buffer_load_dwordx4 v226, s[40:43], s28 offen offset:2048 lds
buffer_load_dwordx4 v227, s[40:43], s28 offen offset:3072 lds
s_waitcnt vmcnt(8)
s_barrier
s_add_u32 m0, s48, 49920
s_nop 0
buffer_load_dwordx4 v3, s[36:39], s55 offen lds
buffer_load_dwordx4 v221, s[36:39], s55 offen offset:1040 lds
buffer_load_dwordx4 v222, s[36:39], s55 offen offset:2080 lds
buffer_load_dwordx4 v223, s[36:39], s55 offen offset:3120 lds
s_add_u32 s55, s55, 131072
s_add_u32 m0, s52, 116736
s_nop 0
buffer_load_dwordx4 v3, s[40:43], s56 offen lds
buffer_load_dwordx4 v225, s[40:43], s56 offen offset:1024 lds
buffer_load_dwordx4 v226, s[40:43], s56 offen offset:2048 lds
buffer_load_dwordx4 v227, s[40:43], s56 offen offset:3072 lds
s_add_u32 s56, s56, 131072
s_waitcnt vmcnt(12)
s_barrier
s_add_u32 m0, s48, 16640
s_nop 0
buffer_load_dwordx4 v3, s[36:39], s55 offen lds
buffer_load_dwordx4 v221, s[36:39], s55 offen offset:1040 lds
buffer_load_dwordx4 v222, s[36:39], s55 offen offset:2080 lds
buffer_load_dwordx4 v223, s[36:39], s55 offen offset:3120 lds
s_add_u32 s55, s55, 131072
s_add_u32 m0, s52, 83968
s_nop 0
buffer_load_dwordx4 v3, s[40:43], s56 offen lds
buffer_load_dwordx4 v225, s[40:43], s56 offen offset:1024 lds
buffer_load_dwordx4 v226, s[40:43], s56 offen offset:2048 lds
buffer_load_dwordx4 v227, s[40:43], s56 offen offset:3072 lds
s_add_u32 s56, s56, 131072
s_waitcnt vmcnt(16)
s_barrier
s_waitcnt vmcnt(8)
s_barrier
s_add_u32 m0, s48, 33280
s_nop 0
buffer_load_dwordx4 v3, s[36:39], s55 offen lds
buffer_load_dwordx4 v221, s[36:39], s55 offen offset:1040 lds
buffer_load_dwordx4 v222, s[36:39], s55 offen offset:2080 lds
buffer_load_dwordx4 v223, s[36:39], s55 offen offset:3120 lds
s_add_u32 s55, s55, 131072
s_add_u32 m0, s52, 100352
s_nop 0
buffer_load_dwordx4 v3, s[40:43], s56 offen lds
buffer_load_dwordx4 v225, s[40:43], s56 offen offset:1024 lds
buffer_load_dwordx4 v226, s[40:43], s56 offen offset:2048 lds
buffer_load_dwordx4 v227, s[40:43], s56 offen offset:3072 lds
s_add_u32 s56, s56, 131072
s_waitcnt vmcnt(8)
s_barrier
s_add_u32 m0, s48, 49920
s_nop 0
buffer_load_dwordx4 v3, s[36:39], s55 offen lds
buffer_load_dwordx4 v221, s[36:39], s55 offen offset:1040 lds
buffer_load_dwordx4 v222, s[36:39], s55 offen offset:2080 lds
buffer_load_dwordx4 v223, s[36:39], s55 offen offset:3120 lds
s_add_u32 s55, s55, 131072
s_add_u32 m0, s52, 116736
s_nop 0
buffer_load_dwordx4 v3, s[40:43], s56 offen lds
buffer_load_dwordx4 v225, s[40:43], s56 offen offset:1024 lds
buffer_load_dwordx4 v226, s[40:43], s56 offen offset:2048 lds
buffer_load_dwordx4 v227, s[40:43], s56 offen offset:3072 lds
s_add_u32 s56, s56, 131072
s_waitcnt vmcnt(8)
s_barrier
s_add_u32 m0, s48, 16640
s_nop 0
buffer_load_dwordx4 v3, s[36:39], s55 offen lds
buffer_load_dwordx4 v221, s[36:39], s55 offen offset:1040 lds
buffer_load_dwordx4 v222, s[36:39], s55 offen offset:2080 lds
buffer_load_dwordx4 v223, s[36:39], s55 offen offset:3120 lds
s_add_u32 s55, s55, 131072
s_add_u32 m0, s52, 83968
s_nop 0
buffer_load_dwordx4 v3, s[40:43], s56 offen lds
buffer_load_dwordx4 v225, s[40:43], s56 offen offset:1024 lds
buffer_load_dwordx4 v226, s[40:43], s56 offen offset:2048 lds
buffer_load_dwordx4 v227, s[40:43], s56 offen offset:3072 lds
s_add_u32 s56, s56, 131072
s_waitcnt vmcnt(8)
s_barrier
s_add_u32 m0, s48, 33280
s_nop 0
buffer_load_dwordx4 v3, s[36:39], s55 offen lds
buffer_load_dwordx4 v221, s[36:39], s55 offen offset:1040 lds
buffer_load_dwordx4 v222, s[36:39], s55 offen offset:2080 lds
buffer_load_dwordx4 v223, s[36:39], s55 offen offset:3120 lds
s_add_u32 s55, s55, 131072
s_add_u32 m0, s52, 100352
s_nop 0
buffer_load_dwordx4 v3, s[40:43], s56 offen lds
buffer_load_dwordx4 v225, s[40:43], s56 offen offset:1024 lds
buffer_load_dwordx4 v226, s[40:43], s56 offen offset:2048 lds
buffer_load_dwordx4 v227, s[40:43], s56 offen offset:3072 lds
s_add_u32 s56, s56, 131072
s_waitcnt vmcnt(8)
s_barrier
s_add_u32 m0, s48, 49920
s_nop 0
buffer_load_dwordx4 v3, s[36:39], s55 offen lds
buffer_load_dwordx4 v221, s[36:39], s55 offen offset:1040 lds
buffer_load_dwordx4 v222, s[36:39], s55 offen offset:2080 lds
buffer_load_dwordx4 v223, s[36:39], s55 offen offset:3120 lds
s_add_u32 s55, s55, 131072
s_add_u32 m0, s52, 116736
s_nop 0
buffer_load_dwordx4 v3, s[40:43], s56 offen lds
buffer_load_dwordx4 v225, s[40:43], s56 offen offset:1024 lds
buffer_load_dwordx4 v226, s[40:43], s56 offen offset:2048 lds
buffer_load_dwordx4 v227, s[40:43], s56 offen offset:3072 lds
s_add_u32 s56, s56, 131072
s_waitcnt vmcnt(8)
s_barrier
s_add_u32 m0, s52, 83968
s_nop 0
buffer_load_dwordx4 v3, s[40:43], s56 offen lds
buffer_load_dwordx4 v225, s[40:43], s56 offen offset:1024 lds
buffer_load_dwordx4 v226, s[40:43], s56 offen offset:2048 lds
buffer_load_dwordx4 v227, s[40:43], s56 offen offset:3072 lds
s_add_u32 s56, s56, 131072
s_waitcnt vmcnt(4)
s_barrier
s_waitcnt vmcnt(0)
s_barrier
s_endpgm
L_ld_M7:
s_mov_b32 s56, s55
s_waitcnt lgkmcnt(0)
s_add_u32 s36, s6, s25
s_addc_u32 s37, s7, 0
s_add_u32 m0, s48, 49920
s_nop 0
buffer_load_dwordx4 v3, s[36:39], s28 offen lds
buffer_load_dwordx4 v221, s[36:39], s28 offen offset:1040 lds
buffer_load_dwordx4 v222, s[36:39], s28 offen offset:2080 lds
buffer_load_dwordx4 v223, s[36:39], s28 offen offset:3120 lds
s_add_u32 s40, s8, s25
s_addc_u32 s41, s9, 0
s_add_u32 m0, s48, 16640
s_nop 0
buffer_load_dwordx4 v3, s[36:39], s55 offen lds
buffer_load_dwordx4 v221, s[36:39], s55 offen offset:1040 lds
buffer_load_dwordx4 v222, s[36:39], s55 offen offset:2080 lds
buffer_load_dwordx4 v223, s[36:39], s55 offen offset:3120 lds
s_add_u32 s55, s55, 131072
s_barrier
s_add_u32 m0, s52, 83968
s_nop 0
buffer_load_dwordx4 v3, s[40:43], s28 offen lds
buffer_load_dwordx4 v225, s[40:43], s28 offen offset:1024 lds
buffer_load_dwordx4 v226, s[40:43], s28 offen offset:2048 lds
buffer_load_dwordx4 v227, s[40:43], s28 offen offset:3072 lds
s_add_u32 m0, s48, 33280
s_nop 0
buffer_load_dwordx4 v3, s[36:39], s55 offen lds
buffer_load_dwordx4 v221, s[36:39], s55 offen offset:1040 lds
buffer_load_dwordx4 v222, s[36:39], s55 offen offset:2080 lds
buffer_load_dwordx4 v223, s[36:39], s55 offen offset:3120 lds
s_add_u32 s55, s55, 131072
s_waitcnt vmcnt(12)
s_barrier
s_add_u32 m0, s52, 100352
s_nop 0
buffer_load_dwordx4 v3, s[40:43], s56 offen lds
buffer_load_dwordx4 v225, s[40:43], s56 offen offset:1024 lds
buffer_load_dwordx4 v226, s[40:43], s56 offen offset:2048 lds
buffer_load_dwordx4 v227, s[40:43], s56 offen offset:3072 lds
s_add_u32 s56, s56, 131072
s_waitcnt vmcnt(12)
s_barrier
s_add_u32 m0, s48, 49920
s_nop 0
buffer_load_dwordx4 v3, s[36:39], s55 offen lds
buffer_load_dwordx4 v221, s[36:39], s55 offen offset:1040 lds
buffer_load_dwordx4 v222, s[36:39], s55 offen offset:2080 lds
buffer_load_dwordx4 v223, s[36:39], s55 offen offset:3120 lds
s_add_u32 s55, s55, 131072
s_add_u32 m0, s52, 116736
s_nop 0
buffer_load_dwordx4 v3, s[40:43], s56 offen lds
buffer_load_dwordx4 v225, s[40:43], s56 offen offset:1024 lds
buffer_load_dwordx4 v226, s[40:43], s56 offen offset:2048 lds
buffer_load_dwordx4 v227, s[40:43], s56 offen offset:3072 lds
s_add_u32 s56, s56, 131072
s_waitcnt vmcnt(16)
s_barrier
s_waitcnt vmcnt(8)
s_barrier
s_add_u32 m0, s48, 16640
s_nop 0
buffer_load_dwordx4 v3, s[36:39], s55 offen lds
buffer_load_dwordx4 v221, s[36:39], s55 offen offset:1040 lds
buffer_load_dwordx4 v222, s[36:39], s55 offen offset:2080 lds
buffer_load_dwordx4 v223, s[36:39], s55 offen offset:3120 lds
s_add_u32 s55, s55, 131072
s_add_u32 m0, s52, 83968
s_nop 0
buffer_load_dwordx4 v3, s[40:43], s56 offen lds
buffer_load_dwordx4 v225, s[40:43], s56 offen offset:1024 lds
buffer_load_dwordx4 v226, s[40:43], s56 offen offset:2048 lds
buffer_load_dwordx4 v227, s[40:43], s56 offen offset:3072 lds
s_add_u32 s56, s56, 131072
s_waitcnt vmcnt(8)
s_barrier
s_add_u32 m0, s48, 33280
s_nop 0
buffer_load_dwordx4 v3, s[36:39], s55 offen lds
buffer_load_dwordx4 v221, s[36:39], s55 offen offset:1040 lds
buffer_load_dwordx4 v222, s[36:39], s55 offen offset:2080 lds
buffer_load_dwordx4 v223, s[36:39], s55 offen offset:3120 lds
s_add_u32 s55, s55, 131072
s_add_u32 m0, s52, 100352
s_nop 0
buffer_load_dwordx4 v3, s[40:43], s56 offen lds
buffer_load_dwordx4 v225, s[40:43], s56 offen offset:1024 lds
buffer_load_dwordx4 v226, s[40:43], s56 offen offset:2048 lds
buffer_load_dwordx4 v227, s[40:43], s56 offen offset:3072 lds
s_add_u32 s56, s56, 131072
s_waitcnt vmcnt(8)
s_barrier
s_add_u32 m0, s48, 49920
s_nop 0
buffer_load_dwordx4 v3, s[36:39], s55 offen lds
buffer_load_dwordx4 v221, s[36:39], s55 offen offset:1040 lds
buffer_load_dwordx4 v222, s[36:39], s55 offen offset:2080 lds
buffer_load_dwordx4 v223, s[36:39], s55 offen offset:3120 lds
s_add_u32 s55, s55, 131072
s_add_u32 m0, s52, 116736
s_nop 0
buffer_load_dwordx4 v3, s[40:43], s56 offen lds
buffer_load_dwordx4 v225, s[40:43], s56 offen offset:1024 lds
buffer_load_dwordx4 v226, s[40:43], s56 offen offset:2048 lds
buffer_load_dwordx4 v227, s[40:43], s56 offen offset:3072 lds
s_add_u32 s56, s56, 131072
s_waitcnt vmcnt(8)
s_barrier
s_add_u32 m0, s52, 83968
s_nop 0
buffer_load_dwordx4 v3, s[40:43], s56 offen lds
buffer_load_dwordx4 v225, s[40:43], s56 offen offset:1024 lds
buffer_load_dwordx4 v226, s[40:43], s56 offen offset:2048 lds
buffer_load_dwordx4 v227, s[40:43], s56 offen offset:3072 lds
s_add_u32 s56, s56, 131072
s_waitcnt vmcnt(4)
s_barrier
s_waitcnt vmcnt(0)
s_barrier
s_endpgm
.p2align 6
L_compute:
s_setprio 1
s_lshl_b32 s21, s16, 2
s_cmp_eq_u32 s16, 2
s_cselect_b32 s21, s29, s21
s_cselect_b32 s24, 4, 0
s_add_u32 s21, s21, s24
s_cmp_eq_u32 s16, 3
s_cselect_b32 s21, 0, s21
s_add_u32 s21, s21, s3
s_cmp_lt_u32 s16, 10
s_cselect_b32 s24, 4, 10
s_sub_u32 s24, s16, s24
s_lshl_b32 s24, s24, 1
s_lshr_b32 s30, s3, 1
s_add_u32 s24, s24, s30
s_cmp_ge_u32 s16, 4
s_cselect_b32 s59, 1, 0
s_cselect_b32 s21, s24, s21
s_cselect_b32 s24, s29, 0
s_lshl_b32 s31, s21, 17
s_lshr_b32 s30, s3, 1
s_mul_i32 s30, s30, 8704
s_add_u32 s50, s30, 133120
s_add_u32 s48, s30, 66560
s_bitcmp1_b32 s3, 0
s_cselect_b32 s48, s48, s50
s_cmp_lg_u32 s24, 0
s_cselect_b32 s50, s50, s48
s_mul_i32 s30, s24, 4160
s_add_u32 s49, s50, s30
s_lshl_b32 s24, s24, 16
s_add_u32 s51, s31, s24
s_mov_b32 m0, s49
s_mov_b32 s34, s26
s_mov_b32 s35, 0x00020000
s_waitcnt lgkmcnt(0)
s_add_u32 s32, s4, s25
s_addc_u32 s33, s5, 0
s_cmp_lg_u32 s59, 0
s_cbranch_scc1 L_q1
buffer_load_dwordx4 v3, s[32:35], s51 offen lds
buffer_load_dwordx4 v221, s[32:35], s51 offen offset:1040 lds
buffer_load_dwordx4 v222, s[32:35], s51 offen offset:2080 lds
buffer_load_dwordx4 v223, s[32:35], s51 offen offset:3120 lds
s_add_u32 m0, s49, 4160
s_add_u32 s51, s51, 65536
buffer_load_dwordx4 v3, s[32:35], s51 offen lds
buffer_load_dwordx4 v221, s[32:35], s51 offen offset:1040 lds
buffer_load_dwordx4 v222, s[32:35], s51 offen offset:2080 lds
buffer_load_dwordx4 v223, s[32:35], s51 offen offset:3120 lds
L_q1:
s_add_u32 s44, s10, s25
s_addc_u32 s45, s11, 0
s_mov_b32 s46, s26
s_mov_b32 s47, 0x00020000
s_add_u32 s36, s6, s25
s_addc_u32 s37, s7, 0
s_mov_b32 s38, s26
s_mov_b32 s39, 0x00020000
s_add_u32 s40, s8, s25
s_addc_u32 s41, s9, 0
s_mov_b32 s42, s26
s_mov_b32 s43, 0x00020000
s_lshl_b32 s24, s27, 5
s_sub_u32 s23, s19, s24
s_cmp_lt_u32 s16, 10
s_cselect_b32 s24, 32, 0
s_and_b32 s30, s59, s29
s_cselect_b32 s23, s24, s23
s_xor_b32 s30, s29, 1
s_and_b32 s30, s30, s59
s_cmp_eq_u32 s16, 2
s_cselect_b32 s28, 1, s59
s_lshr_b32 s24, s22, 2
s_cmp_lg_u32 s28, 0
s_cselect_b32 s29, s29, s24
s_cselect_b32 s54, 0, 8320
s_cselect_b32 s55, 0, 8192
s_cselect_b32 s56, s29, 0
s_cselect_b32 s24, 4, 5
s_cmp_eq_u32 s22, 0
s_cselect_b32 s24, s24, s29
s_cmp_eq_u32 s22, 4
s_cselect_b32 s27, 1, 0
s_cselect_b32 s57, -1, 1
s_mul_i32 s54, s54, s57
s_mul_i32 s55, s55, s57
s_add_u32 s57, s56, 4
s_cmp_lg_u32 s59, 0
s_cselect_b32 s54, -16640, s54
s_cselect_b32 s55, -16384, s55
s_cselect_b32 s80, -3, -1
s_cselect_b32 s56, s57, s56
s_lshl_b32 s57, s30, 7
s_add_u32 s92, s31, s57
s_add_u32 s93, s92, 65536
s_xor_b32 s94, s92, 128
s_xor_b32 s95, s93, 128
v_and_b32 v216, 31, v0
v_lshrrev_b32 v217, 5, v0
v_and_b32 v218, 3, v0
v_lshrrev_b32 v219, 2, v216
v_mul_u32_u24 v1, 1040, v219
v_lshl_add_u32 v1, v218, 6, v1
v_lshl_add_u32 v1, v217, 4, v1
v_add_u32 v210, s50, v1
s_mul_i32 s24, s24, 8320
s_add_u32 s24, s24, 16640
v_add_u32 v211, s24, v1
s_mul_i32 s24, s29, 8320
s_add_u32 s24, s24, 16640
v_add_u32 v1, s24, v1
s_lshr_b32 s24, s3, 1
s_mul_i32 s24, s24, 17408
s_add_u32 s24, s24, 199680
s_sub_u32 s24, s24, s48
v_lshl_add_u32 v220, v0, 4, s48
v_lshl_add_u32 v2, v0, 4, s24
v_lshl_add_u32 v224, v216, 2, s48
v_lshl_add_u32 v225, v216, 2, s24
s_cmp_lg_u32 s59, 0
s_cselect_b32 s58, s24, s48
v_mul_u32_u24 v6, 272, v216
v_lshl_add_u32 v6, v217, 5, v6
v_add_u32 v6, s58, v6
v_lshrrev_b32 v208, 1, v219
v_xor_b32 v208, v208, v219
v_lshrrev_b32 v7, 2, v219
v_xor_b32 v208, v208, v7
v_and_b32 v208, 1, v208
v_and_b32 v7, 3, v219
v_lshl_add_u32 v208, v7, 2, v208
v_lshl_add_u32 v208, v217, 1, v208
v_mul_u32_u24 v7, 272, v208
v_lshl_add_u32 v7, v218, 4, v7
v_add_u32 v7, s58, v7
v_lshlrev_b32 v208, 12, v208
v_lshl_add_u32 v208, v218, 4, v208
v_and_b32 v219, 1, v0
v_lshlrev_b32 v4, 5, v219
v_lshl_add_u32 v4, v217, 10, v4
v_bfe_u32 v219, v0, 2, 2
v_lshl_add_u32 v4, v219, 6, v4
v_bfe_u32 v219, v0, 4, 1
v_lshl_add_u32 v4, v219, 4, v4
v_bfe_u32 v219, v0, 1, 1
v_lshl_add_u32 v4, v219, 3, v4
s_lshl_b32 s24, s29, 13
s_add_u32 s24, s24, 83968
s_lshl_b32 s21, s30, 9
s_xor_b32 s57, s21, 512
s_add_u32 s57, s57, s24
s_add_u32 s24, s24, s21
v_add_u32 v5, s57, v4
v_add_u32 v4, s24, v4
v_lshlrev_b32 v218, 2, v217
v_sub_u32 v218, s23, v218
v_mov_b32 v216, 0xff800000
v_cmp_lt_i32 vcc, 0, v218
s_nop 1
v_cndmask_b32 v72, v216, 0, vcc
v_cndmask_b32 v88, v216, 0, vcc
v_cmp_lt_i32 vcc, 1, v218
s_nop 1
v_cndmask_b32 v73, v216, 0, vcc
v_cndmask_b32 v89, v216, 0, vcc
v_cmp_lt_i32 vcc, 2, v218
s_nop 1
v_cndmask_b32 v74, v216, 0, vcc
v_cndmask_b32 v90, v216, 0, vcc
v_cmp_lt_i32 vcc, 3, v218
s_nop 1
v_cndmask_b32 v75, v216, 0, vcc
v_cndmask_b32 v91, v216, 0, vcc
v_cmp_lt_i32 vcc, 8, v218
s_nop 1
v_cndmask_b32 v76, v216, 0, vcc
v_cndmask_b32 v92, v216, 0, vcc
v_cmp_lt_i32 vcc, 9, v218
s_nop 1
v_cndmask_b32 v77, v216, 0, vcc
v_cndmask_b32 v93, v216, 0, vcc
v_cmp_lt_i32 vcc, 10, v218
s_nop 1
v_cndmask_b32 v78, v216, 0, vcc
v_cndmask_b32 v94, v216, 0, vcc
v_cmp_lt_i32 vcc, 11, v218
s_nop 1
v_cndmask_b32 v79, v216, 0, vcc
v_cndmask_b32 v95, v216, 0, vcc
v_cmp_lt_i32 vcc, 16, v218
s_nop 1
v_cndmask_b32 v80, v216, 0, vcc
v_cndmask_b32 v96, v216, 0, vcc
v_cmp_lt_i32 vcc, 17, v218
s_nop 1
v_cndmask_b32 v81, v216, 0, vcc
v_cndmask_b32 v97, v216, 0, vcc
v_cmp_lt_i32 vcc, 18, v218
s_nop 1
v_cndmask_b32 v82, v216, 0, vcc
v_cndmask_b32 v98, v216, 0, vcc
v_cmp_lt_i32 vcc, 19, v218
s_nop 1
v_cndmask_b32 v83, v216, 0, vcc
v_cndmask_b32 v99, v216, 0, vcc
v_cmp_lt_i32 vcc, 24, v218
s_nop 1
v_cndmask_b32 v84, v216, 0, vcc
v_cndmask_b32 v100, v216, 0, vcc
v_cmp_lt_i32 vcc, 25, v218
s_nop 1
v_cndmask_b32 v85, v216, 0, vcc
v_cndmask_b32 v101, v216, 0, vcc
v_cmp_lt_i32 vcc, 26, v218
s_nop 1
v_cndmask_b32 v86, v216, 0, vcc
v_cndmask_b32 v102, v216, 0, vcc
v_cmp_lt_i32 vcc, 27, v218
s_nop 1
v_cndmask_b32 v87, v216, 0, vcc
v_cndmask_b32 v103, v216, 0, vcc
v_mov_b32 v8, 0
v_mov_b32 v9, 0
v_mov_b32 v10, 0
v_mov_b32 v11, 0
v_mov_b32 v12, 0
v_mov_b32 v13, 0
v_mov_b32 v14, 0
v_mov_b32 v15, 0
v_mov_b32 v16, 0
v_mov_b32 v17, 0
v_mov_b32 v18, 0
v_mov_b32 v19, 0
v_mov_b32 v20, 0
v_mov_b32 v21, 0
v_mov_b32 v22, 0
v_mov_b32 v23, 0
v_mov_b32 v24, 0
v_mov_b32 v25, 0
v_mov_b32 v26, 0
v_mov_b32 v27, 0
v_mov_b32 v28, 0
v_mov_b32 v29, 0
v_mov_b32 v30, 0
v_mov_b32 v31, 0
v_mov_b32 v32, 0
v_mov_b32 v33, 0
v_mov_b32 v34, 0
v_mov_b32 v35, 0
v_mov_b32 v36, 0
v_mov_b32 v37, 0
v_mov_b32 v38, 0
v_mov_b32 v39, 0
v_mov_b32 v40, 0
v_mov_b32 v41, 0
v_mov_b32 v42, 0
v_mov_b32 v43, 0
v_mov_b32 v44, 0
v_mov_b32 v45, 0
v_mov_b32 v46, 0
v_mov_b32 v47, 0
v_mov_b32 v48, 0
v_mov_b32 v49, 0
v_mov_b32 v50, 0
v_mov_b32 v51, 0
v_mov_b32 v52, 0
v_mov_b32 v53, 0
v_mov_b32 v54, 0
v_mov_b32 v55, 0
v_mov_b32 v56, 0
v_mov_b32 v57, 0
v_mov_b32 v58, 0
v_mov_b32 v59, 0
v_mov_b32 v60, 0
v_mov_b32 v61, 0
v_mov_b32 v62, 0
v_mov_b32 v63, 0
v_mov_b32 v64, 0
v_mov_b32 v65, 0
v_mov_b32 v66, 0
v_mov_b32 v67, 0
v_mov_b32 v68, 0
v_mov_b32 v69, 0
v_mov_b32 v70, 0
v_mov_b32 v71, 0
v_mov_b32 v212, 0
v_mov_b32 v213, 0
v_mov_b32 v214, 0
v_mov_b32 v215, 0
v_lshrrev_b32 v218, 2, v0
v_xor_b32 v218, v218, v0
v_bfe_u32 v218, v218, 2, 1
v_subrev_u32 v218, 1, v218
v_and_b32 v228, 0x3f803f80, v218
v_and_b32 v229, 0x3f803f80, v218
v_and_b32 v230, 0x3f803f80, v218
v_and_b32 v231, 0x3f803f80, v218
s_mov_b32 s52, 0x3e0293ee
s_mov_b32 s53, s52
s_cmp_eq_u32 s59, 0
s_cbranch_scc1 L_q2
s_barrier
buffer_load_dwordx4 v3, s[32:35], s51 offen lds
buffer_load_dwordx4 v221, s[32:35], s51 offen offset:1040 lds
buffer_load_dwordx4 v222, s[32:35], s51 offen offset:2080 lds
buffer_load_dwordx4 v223, s[32:35], s51 offen offset:3120 lds
L_q2:
s_cmp_eq_u32 s22, 0
s_cselect_b32 s81, s28, 0
s_cmp_eq_u32 s81, 0
s_cbranch_scc1 L_nox
s_barrier
L_nox:
s_waitcnt vmcnt(0)
s_barrier
ds_read_b128 v[104:107], v210 offset:0
ds_read_b128 v[168:171], v211 offset:0
ds_read_b128 v[108:111], v210 offset:32
ds_read_b128 v[172:175], v211 offset:32
ds_read_b128 v[112:115], v210 offset:256
ds_read_b128 v[176:179], v211 offset:256
ds_read_b128 v[116:119], v210 offset:288
ds_read_b128 v[180:183], v211 offset:288
ds_read_b128 v[120:123], v210 offset:512
ds_read_b128 v[184:187], v211 offset:512
s_cmp_eq_u32 s22, 1
s_cbranch_scc1 L_pro1
s_cmp_eq_u32 s22, 0
s_cbranch_scc1 L_pro0
s_waitcnt lgkmcnt(8)
v_mfma_f32_32x32x16_bf16 v[72:87], v[168:171], v[104:107], v[72:87]
ds_read_b128 v[124:127], v210 offset:544
ds_read_b128 v[188:191], v211 offset:544
s_waitcnt lgkmcnt(8)
v_mfma_f32_32x32x16_bf16 v[72:87], v[172:175], v[108:111], v[72:87]
ds_read_b128 v[128:131], v210 offset:768
ds_read_b128 v[192:195], v211 offset:768
s_waitcnt lgkmcnt(8)
v_mfma_f32_32x32x16_bf16 v[72:87], v[176:179], v[112:115], v[72:87]
ds_read_b128 v[132:135], v210 offset:800
ds_read_b128 v[196:199], v211 offset:800
s_waitcnt lgkmcnt(8)
v_mfma_f32_32x32x16_bf16 v[72:87], v[180:183], v[116:119], v[72:87]
s_waitcnt lgkmcnt(6)
v_mfma_f32_32x32x16_bf16 v[72:87], v[184:187], v[120:123], v[72:87]
s_waitcnt lgkmcnt(0)
s_barrier
ds_read_b128 v[136:139], v1 offset:16640
ds_read_b128 v[140:143], v1 offset:16672
v_mfma_f32_32x32x16_bf16 v[72:87], v[188:191], v[124:127], v[72:87]
ds_read_b128 v[144:147], v1 offset:16896
ds_read_b128 v[148:151], v1 offset:16928
v_mfma_f32_32x32x16_bf16 v[72:87], v[192:195], v[128:131], v[72:87]
ds_read_b128 v[152:155], v1 offset:17152
ds_read_b128 v[156:159], v1 offset:17184
v_mfma_f32_32x32x16_bf16 v[72:87], v[196:199], v[132:135], v[72:87]
ds_read_b128 v[160:163], v1 offset:17408
ds_read_b128 v[164:167], v1 offset:17440
s_waitcnt lgkmcnt(6)
v_mfma_f32_32x32x16_bf16 v[88:103], v[136:139], v[104:107], 0
s_nop 3
v_mul_f32 v72, s52, v72
v_mul_f32 v73, s52, v73
v_mul_f32 v74, s52, v74
v_exp_f32 v72, v72
v_mfma_f32_32x32x16_bf16 v[88:103], v[140:143], v[108:111], v[88:103]
v_mul_f32 v75, s52, v75
v_exp_f32 v73, v73
v_mul_f32 v76, s52, v76
v_exp_f32 v74, v74
s_waitcnt lgkmcnt(4)
v_mfma_f32_32x32x16_bf16 v[88:103], v[144:147], v[112:115], v[88:103]
v_mul_f32 v77, s52, v77
v_exp_f32 v75, v75
v_mul_f32 v78, s52, v78
v_exp_f32 v76, v76
v_cvt_pk_bf16_f32 v200, v72, v73
v_mfma_f32_32x32x16_bf16 v[88:103], v[148:151], v[116:119], v[88:103]
s_waitcnt lgkmcnt(0)
s_barrier
ds_read_b64_tr_b16 v[168:169], v4 offset:16384
ds_read_b64_tr_b16 v[170:171], v4 offset:18432
ds_read_b64_tr_b16 v[172:173], v4 offset:16640
ds_read_b64_tr_b16 v[174:175], v4 offset:18688
v_mul_f32 v79, s52, v79
v_exp_f32 v77, v77
v_mul_f32 v80, s52, v80
v_exp_f32 v78, v78
v_cvt_pk_bf16_f32 v201, v74, v75
v_mfma_f32_32x32x16_bf16 v[88:103], v[152:155], v[120:123], v[88:103]
ds_read_b64_tr_b16 v[176:177], v5 offset:16384
ds_read_b64_tr_b16 v[178:179], v5 offset:18432
ds_read_b64_tr_b16 v[180:181], v5 offset:16640
ds_read_b64_tr_b16 v[182:183], v5 offset:18688
v_mul_f32 v81, s52, v81
v_exp_f32 v79, v79
v_mul_f32 v82, s52, v82
v_exp_f32 v80, v80
v_cvt_pk_bf16_f32 v202, v76, v77
v_mfma_f32_32x32x16_bf16 v[88:103], v[156:159], v[124:127], v[88:103]
ds_read_b64_tr_b16 v[184:185], v4 offset:20480
ds_read_b64_tr_b16 v[186:187], v4 offset:22528
ds_read_b64_tr_b16 v[188:189], v4 offset:20736
ds_read_b64_tr_b16 v[190:191], v4 offset:22784
v_mul_f32 v83, s52, v83
v_exp_f32 v81, v81
v_mul_f32 v84, s52, v84
v_exp_f32 v82, v82
v_cvt_pk_bf16_f32 v203, v78, v79
v_mfma_f32_32x32x16_bf16 v[88:103], v[160:163], v[128:131], v[88:103]
s_waitcnt lgkmcnt(8)
ds_read_b64_tr_b16 v[192:193], v5 offset:20480
ds_read_b64_tr_b16 v[194:195], v5 offset:22528
ds_read_b64_tr_b16 v[196:197], v5 offset:20736
ds_read_b64_tr_b16 v[198:199], v5 offset:22784
v_mul_f32 v85, s52, v85
v_exp_f32 v83, v83
v_mul_f32 v86, s52, v86
v_exp_f32 v84, v84
v_cvt_pk_bf16_f32 v204, v80, v81
v_mfma_f32_32x32x16_bf16 v[88:103], v[164:167], v[132:135], v[88:103]
v_exp_f32 v85, v85
v_cvt_pk_bf16_f32 v205, v82, v83
v_mul_f32 v87, s52, v87
v_exp_f32 v86, v86
s_branch L_mid4
L_pro0:
s_waitcnt lgkmcnt(8)
v_mfma_f32_32x32x16_bf16 v[72:87], v[168:171], v[104:107], v[72:87]
ds_read_b128 v[124:127], v210 offset:544
ds_read_b128 v[188:191], v211 offset:544
s_waitcnt lgkmcnt(8)
v_mfma_f32_32x32x16_bf16 v[72:87], v[172:175], v[108:111], v[72:87]
ds_read_b128 v[128:131], v210 offset:768
ds_read_b128 v[192:195], v211 offset:768
s_waitcnt lgkmcnt(8)
v_mfma_f32_32x32x16_bf16 v[72:87], v[176:179], v[112:115], v[72:87]
ds_read_b128 v[132:135], v210 offset:800
ds_read_b128 v[196:199], v211 offset:800
s_waitcnt lgkmcnt(8)
v_mfma_f32_32x32x16_bf16 v[72:87], v[180:183], v[116:119], v[72:87]
s_waitcnt lgkmcnt(6)
v_mfma_f32_32x32x16_bf16 v[72:87], v[184:187], v[120:123], v[72:87]
s_waitcnt lgkmcnt(0)
s_barrier
ds_read_b128 v[136:139], v1 offset:0
ds_read_b128 v[140:143], v1 offset:32
v_mfma_f32_32x32x16_bf16 v[72:87], v[188:191], v[124:127], v[72:87]
ds_read_b128 v[144:147], v1 offset:256
ds_read_b128 v[148:151], v1 offset:288
v_mfma_f32_32x32x16_bf16 v[72:87], v[192:195], v[128:131], v[72:87]
ds_read_b128 v[152:155], v1 offset:512
ds_read_b128 v[156:159], v1 offset:544
v_mfma_f32_32x32x16_bf16 v[72:87], v[196:199], v[132:135], v[72:87]
ds_read_b128 v[160:163], v1 offset:768
ds_read_b128 v[164:167], v1 offset:800
s_waitcnt lgkmcnt(6)
v_mfma_f32_32x32x16_bf16 v[88:103], v[136:139], v[104:107], 0
s_nop 3
v_mul_f32 v72, s52, v72
v_mul_f32 v73, s52, v73
v_mul_f32 v74, s52, v74
v_exp_f32 v72, v72
v_mfma_f32_32x32x16_bf16 v[88:103], v[140:143], v[108:111], v[88:103]
v_mul_f32 v75, s52, v75
v_exp_f32 v73, v73
v_mul_f32 v76, s52, v76
v_exp_f32 v74, v74
s_waitcnt lgkmcnt(4)
v_mfma_f32_32x32x16_bf16 v[88:103], v[144:147], v[112:115], v[88:103]
v_mul_f32 v77, s52, v77
v_exp_f32 v75, v75
v_mul_f32 v78, s52, v78
v_exp_f32 v76, v76
v_cvt_pk_bf16_f32 v200, v72, v73
v_mfma_f32_32x32x16_bf16 v[88:103], v[148:151], v[116:119], v[88:103]
s_waitcnt lgkmcnt(0)
s_barrier
ds_read_b64_tr_b16 v[168:169], v4 offset:0
ds_read_b64_tr_b16 v[170:171], v4 offset:2048
ds_read_b64_tr_b16 v[172:173], v4 offset:256
ds_read_b64_tr_b16 v[174:175], v4 offset:2304
v_mul_f32 v79, s52, v79
v_exp_f32 v77, v77
v_mul_f32 v80, s52, v80
v_exp_f32 v78, v78
v_cvt_pk_bf16_f32 v201, v74, v75
v_mfma_f32_32x32x16_bf16 v[88:103], v[152:155], v[120:123], v[88:103]
ds_read_b64_tr_b16 v[176:177], v5 offset:0
ds_read_b64_tr_b16 v[178:179], v5 offset:2048
ds_read_b64_tr_b16 v[180:181], v5 offset:256
ds_read_b64_tr_b16 v[182:183], v5 offset:2304
v_mul_f32 v81, s52, v81
v_exp_f32 v79, v79
v_mul_f32 v82, s52, v82
v_exp_f32 v80, v80
v_cvt_pk_bf16_f32 v202, v76, v77
v_mfma_f32_32x32x16_bf16 v[88:103], v[156:159], v[124:127], v[88:103]
ds_read_b64_tr_b16 v[184:185], v4 offset:4096
ds_read_b64_tr_b16 v[186:187], v4 offset:6144
ds_read_b64_tr_b16 v[188:189], v4 offset:4352
ds_read_b64_tr_b16 v[190:191], v4 offset:6400
v_mul_f32 v83, s52, v83
v_exp_f32 v81, v81
v_mul_f32 v84, s52, v84
v_exp_f32 v82, v82
v_cvt_pk_bf16_f32 v203, v78, v79
v_mfma_f32_32x32x16_bf16 v[88:103], v[160:163], v[128:131], v[88:103]
s_waitcnt lgkmcnt(8)
ds_read_b64_tr_b16 v[192:193], v5 offset:4096
ds_read_b64_tr_b16 v[194:195], v5 offset:6144
ds_read_b64_tr_b16 v[196:197], v5 offset:4352
ds_read_b64_tr_b16 v[198:199], v5 offset:6400
v_mul_f32 v85, s52, v85
v_exp_f32 v83, v83
v_mul_f32 v86, s52, v86
v_exp_f32 v84, v84
v_cvt_pk_bf16_f32 v204, v80, v81
v_mfma_f32_32x32x16_bf16 v[88:103], v[164:167], v[132:135], v[88:103]
v_exp_f32 v85, v85
v_cvt_pk_bf16_f32 v205, v82, v83
v_mul_f32 v87, s52, v87
v_exp_f32 v86, v86
s_branch L_mid0
L_pro1:
s_waitcnt lgkmcnt(8)
v_mfma_f32_32x32x16_bf16 v[88:103], v[168:171], v[104:107], v[88:103]
ds_read_b128 v[124:127], v210 offset:544
ds_read_b128 v[188:191], v211 offset:544
s_waitcnt lgkmcnt(8)
v_mfma_f32_32x32x16_bf16 v[88:103], v[172:175], v[108:111], v[88:103]
ds_read_b128 v[128:131], v210 offset:768
ds_read_b128 v[192:195], v211 offset:768
s_waitcnt lgkmcnt(8)
v_mfma_f32_32x32x16_bf16 v[88:103], v[176:179], v[112:115], v[88:103]
ds_read_b128 v[132:135], v210 offset:800
ds_read_b128 v[196:199], v211 offset:800
s_waitcnt lgkmcnt(8)
v_mfma_f32_32x32x16_bf16 v[88:103], v[180:183], v[116:119], v[88:103]
s_waitcnt lgkmcnt(6)
v_mfma_f32_32x32x16_bf16 v[88:103], v[184:187], v[120:123], v[88:103]
s_waitcnt lgkmcnt(0)
s_barrier
ds_read_b128 v[136:139], v1 offset:16640
ds_read_b128 v[140:143], v1 offset:16672
v_mfma_f32_32x32x16_bf16 v[88:103], v[188:191], v[124:127], v[88:103]
ds_read_b128 v[144:147], v1 offset:16896
ds_read_b128 v[148:151], v1 offset:16928
v_mfma_f32_32x32x16_bf16 v[88:103], v[192:195], v[128:131], v[88:103]
ds_read_b128 v[152:155], v1 offset:17152
ds_read_b128 v[156:159], v1 offset:17184
v_mfma_f32_32x32x16_bf16 v[88:103], v[196:199], v[132:135], v[88:103]
ds_read_b128 v[160:163], v1 offset:17408
ds_read_b128 v[164:167], v1 offset:17440
s_waitcnt lgkmcnt(6)
v_mfma_f32_32x32x16_bf16 v[72:87], v[136:139], v[104:107], 0
s_nop 3
v_mul_f32 v88, s52, v88
v_mul_f32 v89, s52, v89
v_mul_f32 v90, s52, v90
v_exp_f32 v88, v88
v_mfma_f32_32x32x16_bf16 v[72:87], v[140:143], v[108:111], v[72:87]
v_mul_f32 v91, s52, v91
v_exp_f32 v89, v89
v_mul_f32 v92, s52, v92
v_exp_f32 v90, v90
s_waitcnt lgkmcnt(4)
v_mfma_f32_32x32x16_bf16 v[72:87], v[144:147], v[112:115], v[72:87]
v_mul_f32 v93, s52, v93
v_exp_f32 v91, v91
v_mul_f32 v94, s52, v94
v_exp_f32 v92, v92
v_cvt_pk_bf16_f32 v200, v88, v89
v_mfma_f32_32x32x16_bf16 v[72:87], v[148:151], v[116:119], v[72:87]
s_waitcnt lgkmcnt(0)
s_barrier
ds_read_b64_tr_b16 v[168:169], v4 offset:16384
ds_read_b64_tr_b16 v[170:171], v4 offset:18432
ds_read_b64_tr_b16 v[172:173], v4 offset:16640
ds_read_b64_tr_b16 v[174:175], v4 offset:18688
v_mul_f32 v95, s52, v95
v_exp_f32 v93, v93
v_mul_f32 v96, s52, v96
v_exp_f32 v94, v94
v_cvt_pk_bf16_f32 v201, v90, v91
v_mfma_f32_32x32x16_bf16 v[72:87], v[152:155], v[120:123], v[72:87]
ds_read_b64_tr_b16 v[176:177], v5 offset:16384
ds_read_b64_tr_b16 v[178:179], v5 offset:18432
ds_read_b64_tr_b16 v[180:181], v5 offset:16640
ds_read_b64_tr_b16 v[182:183], v5 offset:18688
v_mul_f32 v97, s52, v97
v_exp_f32 v95, v95
v_mul_f32 v98, s52, v98
v_exp_f32 v96, v96
v_cvt_pk_bf16_f32 v202, v92, v93
v_mfma_f32_32x32x16_bf16 v[72:87], v[156:159], v[124:127], v[72:87]
ds_read_b64_tr_b16 v[184:185], v4 offset:20480
ds_read_b64_tr_b16 v[186:187], v4 offset:22528
ds_read_b64_tr_b16 v[188:189], v4 offset:20736
ds_read_b64_tr_b16 v[190:191], v4 offset:22784
v_mul_f32 v99, s52, v99
v_exp_f32 v97, v97
v_mul_f32 v100, s52, v100
v_exp_f32 v98, v98
v_cvt_pk_bf16_f32 v203, v94, v95
v_mfma_f32_32x32x16_bf16 v[72:87], v[160:163], v[128:131], v[72:87]
s_waitcnt lgkmcnt(8)
ds_read_b64_tr_b16 v[192:193], v5 offset:20480
ds_read_b64_tr_b16 v[194:195], v5 offset:22528
ds_read_b64_tr_b16 v[196:197], v5 offset:20736
ds_read_b64_tr_b16 v[198:199], v5 offset:22784
v_mul_f32 v101, s52, v101
v_exp_f32 v99, v99
v_mul_f32 v102, s52, v102
v_exp_f32 v100, v100
v_cvt_pk_bf16_f32 v204, v96, v97
v_mfma_f32_32x32x16_bf16 v[72:87], v[164:167], v[132:135], v[72:87]
v_exp_f32 v101, v101
v_cvt_pk_bf16_f32 v205, v98, v99
v_mul_f32 v103, s52, v103
v_exp_f32 v102, v102
s_branch L_mid1
L_body0:
v_mfma_f32_32x32x16_bf16 v[8:23], v[184:187], v[204:207], v[8:23]
ds_read_b128 v[152:155], v1 offset:512
ds_read_b64_tr_b16 v[170:171], v4 offset:2048
v_mul_f32 v75, s52, v75
v_exp_f32 v74, v74
s_mul_i32 s54, s54, s80
v_mfma_f32_32x32x16_bf16 v[24:39], v[188:191], v[204:207], v[24:39]
ds_read_b128 v[156:159], v1 offset:544
ds_read_b64_tr_b16 v[174:175], v4 offset:2304
v_mul_f32 v76, s52, v76
v_exp_f32 v75, v75
s_mul_i32 s55, s55, s80
v_mfma_f32_32x32x16_bf16 v[40:55], v[192:195], v[204:207], v[40:55]
ds_read_b128 v[160:163], v1 offset:768
ds_read_b64_tr_b16 v[178:179], v5 offset:2048
v_mul_f32 v77, s52, v77
v_exp_f32 v76, v76
s_waitcnt lgkmcnt(6)
v_mfma_f32_32x32x16_bf16 v[56:71], v[196:199], v[204:207], v[56:71]
ds_read_b128 v[164:167], v1 offset:800
ds_read_b64_tr_b16 v[182:183], v5 offset:2304
v_mul_f32 v78, s52, v78
v_exp_f32 v77, v77
v_mfma_f32_16x16x32_bf16 v[212:215], v[228:231], v[204:207], v[212:215]
v_cvt_pk_bf16_f32 v200, v72, v73
v_cvt_pk_bf16_f32 v201, v74, v75
v_mfma_f32_32x32x16_bf16 v[88:103], v[136:139], v[104:107], 0
ds_read_b64_tr_b16 v[184:185], v4 offset:4096
ds_read_b64_tr_b16 v[186:187], v4 offset:6144
v_mul_f32 v79, s52, v79
v_exp_f32 v78, v78
v_mfma_f32_32x32x16_bf16 v[88:103], v[140:143], v[108:111], v[88:103]
ds_read_b64_tr_b16 v[188:189], v4 offset:4352
v_mul_f32 v80, s52, v80
v_cvt_pk_bf16_f32 v202, v76, v77
v_exp_f32 v79, v79
v_mfma_f32_32x32x16_bf16 v[88:103], v[144:147], v[112:115], v[88:103]
ds_read_b64_tr_b16 v[190:191], v4 offset:6400
ds_read_b64_tr_b16 v[192:193], v5 offset:4096
v_mul_f32 v81, s52, v81
v_exp_f32 v80, v80
v_mfma_f32_32x32x16_bf16 v[88:103], v[148:151], v[116:119], v[88:103]
ds_read_b64_tr_b16 v[194:195], v5 offset:6144
v_mul_f32 v82, s52, v82
v_cvt_pk_bf16_f32 v203, v78, v79
v_exp_f32 v81, v81
s_waitcnt lgkmcnt(6)
v_mfma_f32_32x32x16_bf16 v[88:103], v[152:155], v[120:123], v[88:103]
ds_read_b64_tr_b16 v[196:197], v5 offset:4352
v_mul_f32 v83, s52, v83
v_cvt_pk_bf16_f32 v204, v80, v81
v_exp_f32 v82, v82
v_mfma_f32_32x32x16_bf16 v[88:103], v[156:159], v[124:127], v[88:103]
ds_read_b64_tr_b16 v[198:199], v5 offset:6400
ds_read_b64_tr_b16 v[180:181], v5 offset:256
v_mul_f32 v84, s52, v84
v_exp_f32 v83, v83
v_mfma_f32_32x32x16_bf16 v[88:103], v[160:163], v[128:131], v[88:103]
v_mul_f32 v85, s52, v85
v_mul_f32 v86, s52, v86
v_exp_f32 v84, v84
v_mfma_f32_32x32x16_bf16 v[88:103], v[164:167], v[132:135], v[88:103]
v_mul_f32 v87, s52, v87
v_cvt_pk_bf16_f32 v205, v82, v83
v_exp_f32 v85, v85
v_exp_f32 v86, v86
L_mid0:
v_mfma_f32_16x16x32_bf16 v[212:215], v[228:231], v[200:203], v[212:215]
v_cvt_pk_bf16_f32 v206, v84, v85
s_waitcnt lgkmcnt(0)
v_mfma_f32_32x32x16_bf16 v[8:23], v[168:171], v[200:203], v[8:23]
s_barrier
ds_read_b128 v[136:139], v1 offset:16640
v_mfma_f32_32x32x16_bf16 v[24:39], v[172:175], v[200:203], v[24:39]
ds_read_b64_tr_b16 v[168:169], v4 offset:16384
ds_read_b128 v[140:143], v1 offset:16672
v_mul_f32 v88, s52, v88
v_exp_f32 v87, v87
v_mfma_f32_32x32x16_bf16 v[40:55], v[176:179], v[200:203], v[40:55]
ds_read_b64_tr_b16 v[172:173], v4 offset:16640
ds_read_b128 v[144:147], v1 offset:16896
v_mul_f32 v89, s52, v89
v_cvt_pk_bf16_f32 v207, v86, v87
v_exp_f32 v88, v88
v_mfma_f32_32x32x16_bf16 v[56:71], v[180:183], v[200:203], v[56:71]
ds_read_b64_tr_b16 v[176:177], v5 offset:16384
ds_read_b128 v[148:151], v1 offset:16928
v_mul_f32 v90, s52, v90
v_exp_f32 v89, v89
L_body1:
v_mfma_f32_32x32x16_bf16 v[8:23], v[184:187], v[204:207], v[8:23]
ds_read_b128 v[152:155], v1 offset:17152
ds_read_b64_tr_b16 v[170:171], v4 offset:18432
v_mul_f32 v91, s52, v91
v_exp_f32 v90, v90
v_mfma_f32_32x32x16_bf16 v[24:39], v[188:191], v[204:207], v[24:39]
ds_read_b128 v[156:159], v1 offset:17184
ds_read_b64_tr_b16 v[174:175], v4 offset:18688
v_mul_f32 v92, s52, v92
v_exp_f32 v91, v91
v_mfma_f32_32x32x16_bf16 v[40:55], v[192:195], v[204:207], v[40:55]
ds_read_b128 v[160:163], v1 offset:17408
ds_read_b64_tr_b16 v[178:179], v5 offset:18432
v_mul_f32 v93, s52, v93
v_exp_f32 v92, v92
s_waitcnt lgkmcnt(6)
v_mfma_f32_32x32x16_bf16 v[56:71], v[196:199], v[204:207], v[56:71]
ds_read_b128 v[164:167], v1 offset:17440
ds_read_b64_tr_b16 v[182:183], v5 offset:18688
v_mul_f32 v94, s52, v94
v_exp_f32 v93, v93
v_mfma_f32_16x16x32_bf16 v[212:215], v[228:231], v[204:207], v[212:215]
v_cvt_pk_bf16_f32 v200, v88, v89
v_cvt_pk_bf16_f32 v201, v90, v91
v_mfma_f32_32x32x16_bf16 v[72:87], v[136:139], v[104:107], 0
ds_read_b64_tr_b16 v[184:185], v4 offset:20480
ds_read_b64_tr_b16 v[186:187], v4 offset:22528
v_mul_f32 v95, s52, v95
v_exp_f32 v94, v94
v_mfma_f32_32x32x16_bf16 v[72:87], v[140:143], v[108:111], v[72:87]
ds_read_b64_tr_b16 v[188:189], v4 offset:20736
v_mul_f32 v96, s52, v96
v_cvt_pk_bf16_f32 v202, v92, v93
v_exp_f32 v95, v95
v_mfma_f32_32x32x16_bf16 v[72:87], v[144:147], v[112:115], v[72:87]
ds_read_b64_tr_b16 v[190:191], v4 offset:22784
ds_read_b64_tr_b16 v[192:193], v5 offset:20480
v_mul_f32 v97, s52, v97
v_exp_f32 v96, v96
v_mfma_f32_32x32x16_bf16 v[72:87], v[148:151], v[116:119], v[72:87]
ds_read_b64_tr_b16 v[194:195], v5 offset:22528
v_mul_f32 v98, s52, v98
v_cvt_pk_bf16_f32 v203, v94, v95
v_exp_f32 v97, v97
s_waitcnt lgkmcnt(6)
v_mfma_f32_32x32x16_bf16 v[72:87], v[152:155], v[120:123], v[72:87]
ds_read_b64_tr_b16 v[196:197], v5 offset:20736
v_mul_f32 v99, s52, v99
v_cvt_pk_bf16_f32 v204, v96, v97
v_exp_f32 v98, v98
v_mfma_f32_32x32x16_bf16 v[72:87], v[156:159], v[124:127], v[72:87]
ds_read_b64_tr_b16 v[198:199], v5 offset:22784
ds_read_b64_tr_b16 v[180:181], v5 offset:16640
v_mul_f32 v100, s52, v100
v_exp_f32 v99, v99
v_mfma_f32_32x32x16_bf16 v[72:87], v[160:163], v[128:131], v[72:87]
v_mul_f32 v101, s52, v101
v_mul_f32 v102, s52, v102
v_exp_f32 v100, v100
v_mfma_f32_32x32x16_bf16 v[72:87], v[164:167], v[132:135], v[72:87]
v_mul_f32 v103, s52, v103
v_cvt_pk_bf16_f32 v205, v98, v99
v_exp_f32 v101, v101
v_exp_f32 v102, v102
L_mid1:
v_mfma_f32_16x16x32_bf16 v[212:215], v[228:231], v[200:203], v[212:215]
v_cvt_pk_bf16_f32 v206, v100, v101
s_waitcnt lgkmcnt(0)
v_mfma_f32_32x32x16_bf16 v[8:23], v[168:171], v[200:203], v[8:23]
s_barrier
ds_read_b128 v[136:139], v1 offset:33280
v_mfma_f32_32x32x16_bf16 v[24:39], v[172:175], v[200:203], v[24:39]
ds_read_b64_tr_b16 v[168:169], v4 offset:32768
ds_read_b128 v[140:143], v1 offset:33312
v_mul_f32 v72, s52, v72
v_exp_f32 v103, v103
v_mfma_f32_32x32x16_bf16 v[40:55], v[176:179], v[200:203], v[40:55]
ds_read_b64_tr_b16 v[172:173], v4 offset:33024
ds_read_b128 v[144:147], v1 offset:33536
v_mul_f32 v73, s52, v73
v_cvt_pk_bf16_f32 v207, v102, v103
v_exp_f32 v72, v72
v_mfma_f32_32x32x16_bf16 v[56:71], v[180:183], v[200:203], v[56:71]
ds_read_b64_tr_b16 v[176:177], v5 offset:32768
ds_read_b128 v[148:151], v1 offset:33568
v_mul_f32 v74, s52, v74
v_exp_f32 v73, v73
L_body2:
v_mfma_f32_32x32x16_bf16 v[8:23], v[184:187], v[204:207], v[8:23]
ds_read_b128 v[152:155], v1 offset:33792
ds_read_b64_tr_b16 v[170:171], v4 offset:34816
v_mul_f32 v75, s52, v75
v_exp_f32 v74, v74
v_mfma_f32_32x32x16_bf16 v[24:39], v[188:191], v[204:207], v[24:39]
ds_read_b128 v[156:159], v1 offset:33824
ds_read_b64_tr_b16 v[174:175], v4 offset:35072
v_mul_f32 v76, s52, v76
v_exp_f32 v75, v75
v_mfma_f32_32x32x16_bf16 v[40:55], v[192:195], v[204:207], v[40:55]
ds_read_b128 v[160:163], v1 offset:34048
ds_read_b64_tr_b16 v[178:179], v5 offset:34816
v_mul_f32 v77, s52, v77
v_exp_f32 v76, v76
s_waitcnt lgkmcnt(6)
v_mfma_f32_32x32x16_bf16 v[56:71], v[196:199], v[204:207], v[56:71]
ds_read_b128 v[164:167], v1 offset:34080
ds_read_b64_tr_b16 v[182:183], v5 offset:35072
v_mul_f32 v78, s52, v78
v_exp_f32 v77, v77
v_mfma_f32_16x16x32_bf16 v[212:215], v[228:231], v[204:207], v[212:215]
v_cvt_pk_bf16_f32 v200, v72, v73
v_cvt_pk_bf16_f32 v201, v74, v75
v_mfma_f32_32x32x16_bf16 v[88:103], v[136:139], v[104:107], 0
ds_read_b64_tr_b16 v[184:185], v4 offset:36864
ds_read_b64_tr_b16 v[186:187], v4 offset:38912
v_mul_f32 v79, s52, v79
v_add_u32 v1, s54, v1
v_exp_f32 v78, v78
v_mfma_f32_32x32x16_bf16 v[88:103], v[140:143], v[108:111], v[88:103]
ds_read_b64_tr_b16 v[188:189], v4 offset:37120
v_mul_f32 v80, s52, v80
v_cvt_pk_bf16_f32 v202, v76, v77
v_exp_f32 v79, v79
v_mfma_f32_32x32x16_bf16 v[88:103], v[144:147], v[112:115], v[88:103]
ds_read_b64_tr_b16 v[190:191], v4 offset:39168
ds_read_b64_tr_b16 v[192:193], v5 offset:36864
v_mul_f32 v81, s52, v81
v_exp_f32 v80, v80
v_mfma_f32_32x32x16_bf16 v[88:103], v[148:151], v[116:119], v[88:103]
ds_read_b64_tr_b16 v[194:195], v5 offset:38912
v_mul_f32 v82, s52, v82
v_cvt_pk_bf16_f32 v203, v78, v79
v_exp_f32 v81, v81
s_waitcnt lgkmcnt(6)
v_mfma_f32_32x32x16_bf16 v[88:103], v[152:155], v[120:123], v[88:103]
ds_read_b64_tr_b16 v[196:197], v5 offset:37120
v_mul_f32 v83, s52, v83
v_cvt_pk_bf16_f32 v204, v80, v81
v_add_u32 v4, s55, v4
v_exp_f32 v82, v82
v_mfma_f32_32x32x16_bf16 v[88:103], v[156:159], v[124:127], v[88:103]
ds_read_b64_tr_b16 v[198:199], v5 offset:39168
ds_read_b64_tr_b16 v[180:181], v5 offset:33024
v_mul_f32 v84, s52, v84
v_exp_f32 v83, v83
v_mfma_f32_32x32x16_bf16 v[88:103], v[160:163], v[128:131], v[88:103]
v_mul_f32 v85, s52, v85
v_mul_f32 v86, s52, v86
v_add_u32 v5, s55, v5
v_exp_f32 v84, v84
v_mfma_f32_32x32x16_bf16 v[88:103], v[164:167], v[132:135], v[88:103]
v_mul_f32 v87, s52, v87
v_cvt_pk_bf16_f32 v205, v82, v83
v_exp_f32 v85, v85
v_exp_f32 v86, v86
L_mid2:
v_mfma_f32_16x16x32_bf16 v[212:215], v[228:231], v[200:203], v[212:215]
v_cvt_pk_bf16_f32 v206, v84, v85
s_waitcnt lgkmcnt(0)
v_mfma_f32_32x32x16_bf16 v[8:23], v[168:171], v[200:203], v[8:23]
s_barrier
ds_read_b128 v[136:139], v1 offset:0
v_mfma_f32_32x32x16_bf16 v[24:39], v[172:175], v[200:203], v[24:39]
ds_read_b64_tr_b16 v[168:169], v4 offset:0
ds_read_b128 v[140:143], v1 offset:32
v_mul_f32 v88, s52, v88
v_exp_f32 v87, v87
v_mfma_f32_32x32x16_bf16 v[40:55], v[176:179], v[200:203], v[40:55]
ds_read_b64_tr_b16 v[172:173], v4 offset:256
ds_read_b128 v[144:147], v1 offset:256
v_mul_f32 v89, s52, v89
v_cvt_pk_bf16_f32 v207, v86, v87
v_exp_f32 v88, v88
v_mfma_f32_32x32x16_bf16 v[56:71], v[180:183], v[200:203], v[56:71]
ds_read_b64_tr_b16 v[176:177], v5 offset:0
ds_read_b128 v[148:151], v1 offset:288
v_mul_f32 v90, s52, v90
v_exp_f32 v89, v89
L_body3:
v_mfma_f32_32x32x16_bf16 v[8:23], v[184:187], v[204:207], v[8:23]
ds_read_b128 v[152:155], v1 offset:512
ds_read_b64_tr_b16 v[170:171], v4 offset:2048
v_mul_f32 v91, s52, v91
v_exp_f32 v90, v90
s_mul_i32 s54, s54, s80
v_mfma_f32_32x32x16_bf16 v[24:39], v[188:191], v[204:207], v[24:39]
ds_read_b128 v[156:159], v1 offset:544
ds_read_b64_tr_b16 v[174:175], v4 offset:2304
v_mul_f32 v92, s52, v92
v_exp_f32 v91, v91
s_mul_i32 s55, s55, s80
v_mfma_f32_32x32x16_bf16 v[40:55], v[192:195], v[204:207], v[40:55]
ds_read_b128 v[160:163], v1 offset:768
ds_read_b64_tr_b16 v[178:179], v5 offset:2048
v_mul_f32 v93, s52, v93
v_exp_f32 v92, v92
s_waitcnt lgkmcnt(6)
v_mfma_f32_32x32x16_bf16 v[56:71], v[196:199], v[204:207], v[56:71]
ds_read_b128 v[164:167], v1 offset:800
ds_read_b64_tr_b16 v[182:183], v5 offset:2304
v_mul_f32 v94, s52, v94
v_exp_f32 v93, v93
v_mfma_f32_16x16x32_bf16 v[212:215], v[228:231], v[204:207], v[212:215]
v_cvt_pk_bf16_f32 v200, v88, v89
v_cvt_pk_bf16_f32 v201, v90, v91
v_mfma_f32_32x32x16_bf16 v[72:87], v[136:139], v[104:107], 0
ds_read_b64_tr_b16 v[184:185], v4 offset:4096
ds_read_b64_tr_b16 v[186:187], v4 offset:6144
v_mul_f32 v95, s52, v95
v_exp_f32 v94, v94
v_mfma_f32_32x32x16_bf16 v[72:87], v[140:143], v[108:111], v[72:87]
ds_read_b64_tr_b16 v[188:189], v4 offset:4352
v_mul_f32 v96, s52, v96
v_cvt_pk_bf16_f32 v202, v92, v93
v_exp_f32 v95, v95
v_mfma_f32_32x32x16_bf16 v[72:87], v[144:147], v[112:115], v[72:87]
ds_read_b64_tr_b16 v[190:191], v4 offset:6400
ds_read_b64_tr_b16 v[192:193], v5 offset:4096
v_mul_f32 v97, s52, v97
v_exp_f32 v96, v96
v_mfma_f32_32x32x16_bf16 v[72:87], v[148:151], v[116:119], v[72:87]
ds_read_b64_tr_b16 v[194:195], v5 offset:6144
v_mul_f32 v98, s52, v98
v_cvt_pk_bf16_f32 v203, v94, v95
v_exp_f32 v97, v97
s_waitcnt lgkmcnt(6)
v_mfma_f32_32x32x16_bf16 v[72:87], v[152:155], v[120:123], v[72:87]
ds_read_b64_tr_b16 v[196:197], v5 offset:4352
v_mul_f32 v99, s52, v99
v_cvt_pk_bf16_f32 v204, v96, v97
v_exp_f32 v98, v98
v_mfma_f32_32x32x16_bf16 v[72:87], v[156:159], v[124:127], v[72:87]
ds_read_b64_tr_b16 v[198:199], v5 offset:6400
ds_read_b64_tr_b16 v[180:181], v5 offset:256
v_mul_f32 v100, s52, v100
v_exp_f32 v99, v99
v_mfma_f32_32x32x16_bf16 v[72:87], v[160:163], v[128:131], v[72:87]
v_mul_f32 v101, s52, v101
v_mul_f32 v102, s52, v102
v_exp_f32 v100, v100
v_mfma_f32_32x32x16_bf16 v[72:87], v[164:167], v[132:135], v[72:87]
v_mul_f32 v103, s52, v103
v_cvt_pk_bf16_f32 v205, v98, v99
v_exp_f32 v101, v101
v_exp_f32 v102, v102
L_mid3:
v_mfma_f32_16x16x32_bf16 v[212:215], v[228:231], v[200:203], v[212:215]
v_cvt_pk_bf16_f32 v206, v100, v101
s_waitcnt lgkmcnt(0)
v_mfma_f32_32x32x16_bf16 v[8:23], v[168:171], v[200:203], v[8:23]
s_barrier
ds_read_b128 v[136:139], v1 offset:16640
v_mfma_f32_32x32x16_bf16 v[24:39], v[172:175], v[200:203], v[24:39]
ds_read_b64_tr_b16 v[168:169], v4 offset:16384
ds_read_b128 v[140:143], v1 offset:16672
v_mul_f32 v72, s52, v72
v_exp_f32 v103, v103
v_mfma_f32_32x32x16_bf16 v[40:55], v[176:179], v[200:203], v[40:55]
ds_read_b64_tr_b16 v[172:173], v4 offset:16640
ds_read_b128 v[144:147], v1 offset:16896
v_mul_f32 v73, s52, v73
v_cvt_pk_bf16_f32 v207, v102, v103
v_exp_f32 v72, v72
v_mfma_f32_32x32x16_bf16 v[56:71], v[180:183], v[200:203], v[56:71]
ds_read_b64_tr_b16 v[176:177], v5 offset:16384
ds_read_b128 v[148:151], v1 offset:16928
v_mul_f32 v74, s52, v74
v_exp_f32 v73, v73
L_body4:
v_mfma_f32_32x32x16_bf16 v[8:23], v[184:187], v[204:207], v[8:23]
ds_read_b128 v[152:155], v1 offset:17152
ds_read_b64_tr_b16 v[170:171], v4 offset:18432
v_mul_f32 v75, s52, v75
v_exp_f32 v74, v74
v_mfma_f32_32x32x16_bf16 v[24:39], v[188:191], v[204:207], v[24:39]
ds_read_b128 v[156:159], v1 offset:17184
ds_read_b64_tr_b16 v[174:175], v4 offset:18688
v_mul_f32 v76, s52, v76
v_exp_f32 v75, v75
v_mfma_f32_32x32x16_bf16 v[40:55], v[192:195], v[204:207], v[40:55]
ds_read_b128 v[160:163], v1 offset:17408
ds_read_b64_tr_b16 v[178:179], v5 offset:18432
v_mul_f32 v77, s52, v77
v_exp_f32 v76, v76
s_waitcnt lgkmcnt(6)
v_mfma_f32_32x32x16_bf16 v[56:71], v[196:199], v[204:207], v[56:71]
ds_read_b128 v[164:167], v1 offset:17440
ds_read_b64_tr_b16 v[182:183], v5 offset:18688
v_mul_f32 v78, s52, v78
v_exp_f32 v77, v77
v_mfma_f32_16x16x32_bf16 v[212:215], v[228:231], v[204:207], v[212:215]
v_cvt_pk_bf16_f32 v200, v72, v73
v_cvt_pk_bf16_f32 v201, v74, v75
v_mfma_f32_32x32x16_bf16 v[88:103], v[136:139], v[104:107], 0
ds_read_b64_tr_b16 v[184:185], v4 offset:20480
ds_read_b64_tr_b16 v[186:187], v4 offset:22528
v_mul_f32 v79, s52, v79
v_exp_f32 v78, v78
v_mfma_f32_32x32x16_bf16 v[88:103], v[140:143], v[108:111], v[88:103]
ds_read_b64_tr_b16 v[188:189], v4 offset:20736
v_mul_f32 v80, s52, v80
v_cvt_pk_bf16_f32 v202, v76, v77
v_exp_f32 v79, v79
v_mfma_f32_32x32x16_bf16 v[88:103], v[144:147], v[112:115], v[88:103]
ds_read_b64_tr_b16 v[190:191], v4 offset:22784
ds_read_b64_tr_b16 v[192:193], v5 offset:20480
v_mul_f32 v81, s52, v81
v_exp_f32 v80, v80
v_mfma_f32_32x32x16_bf16 v[88:103], v[148:151], v[116:119], v[88:103]
ds_read_b64_tr_b16 v[194:195], v5 offset:22528
v_mul_f32 v82, s52, v82
v_cvt_pk_bf16_f32 v203, v78, v79
v_exp_f32 v81, v81
s_waitcnt lgkmcnt(6)
v_mfma_f32_32x32x16_bf16 v[88:103], v[152:155], v[120:123], v[88:103]
ds_read_b64_tr_b16 v[196:197], v5 offset:20736
v_mul_f32 v83, s52, v83
v_cvt_pk_bf16_f32 v204, v80, v81
v_exp_f32 v82, v82
v_mfma_f32_32x32x16_bf16 v[88:103], v[156:159], v[124:127], v[88:103]
ds_read_b64_tr_b16 v[198:199], v5 offset:22784
ds_read_b64_tr_b16 v[180:181], v5 offset:16640
v_mul_f32 v84, s52, v84
v_exp_f32 v83, v83
v_mfma_f32_32x32x16_bf16 v[88:103], v[160:163], v[128:131], v[88:103]
v_mul_f32 v85, s52, v85
v_mul_f32 v86, s52, v86
v_exp_f32 v84, v84
v_mfma_f32_32x32x16_bf16 v[88:103], v[164:167], v[132:135], v[88:103]
v_mul_f32 v87, s52, v87
v_cvt_pk_bf16_f32 v205, v82, v83
v_exp_f32 v85, v85
v_exp_f32 v86, v86
L_mid4:
v_mfma_f32_16x16x32_bf16 v[212:215], v[228:231], v[200:203], v[212:215]
v_cvt_pk_bf16_f32 v206, v84, v85
s_waitcnt lgkmcnt(0)
v_mfma_f32_32x32x16_bf16 v[8:23], v[168:171], v[200:203], v[8:23]
s_barrier
ds_read_b128 v[136:139], v1 offset:33280
v_mfma_f32_32x32x16_bf16 v[24:39], v[172:175], v[200:203], v[24:39]
ds_read_b64_tr_b16 v[168:169], v4 offset:32768
ds_read_b128 v[140:143], v1 offset:33312
v_mul_f32 v88, s52, v88
v_exp_f32 v87, v87
v_mfma_f32_32x32x16_bf16 v[40:55], v[176:179], v[200:203], v[40:55]
ds_read_b64_tr_b16 v[172:173], v4 offset:33024
ds_read_b128 v[144:147], v1 offset:33536
v_mul_f32 v89, s52, v89
v_cvt_pk_bf16_f32 v207, v86, v87
v_exp_f32 v88, v88
v_mfma_f32_32x32x16_bf16 v[56:71], v[180:183], v[200:203], v[56:71]
ds_read_b64_tr_b16 v[176:177], v5 offset:32768
ds_read_b128 v[148:151], v1 offset:33568
v_mul_f32 v90, s52, v90
v_exp_f32 v89, v89
L_body5:
v_mfma_f32_32x32x16_bf16 v[8:23], v[184:187], v[204:207], v[8:23]
ds_read_b128 v[152:155], v1 offset:33792
ds_read_b64_tr_b16 v[170:171], v4 offset:34816
v_mul_f32 v91, s52, v91
v_exp_f32 v90, v90
v_mfma_f32_32x32x16_bf16 v[24:39], v[188:191], v[204:207], v[24:39]
ds_read_b128 v[156:159], v1 offset:33824
ds_read_b64_tr_b16 v[174:175], v4 offset:35072
v_mul_f32 v92, s52, v92
v_exp_f32 v91, v91
v_mfma_f32_32x32x16_bf16 v[40:55], v[192:195], v[204:207], v[40:55]
ds_read_b128 v[160:163], v1 offset:34048
ds_read_b64_tr_b16 v[178:179], v5 offset:34816
v_mul_f32 v93, s52, v93
v_exp_f32 v92, v92
s_waitcnt lgkmcnt(6)
v_mfma_f32_32x32x16_bf16 v[56:71], v[196:199], v[204:207], v[56:71]
ds_read_b128 v[164:167], v1 offset:34080
ds_read_b64_tr_b16 v[182:183], v5 offset:35072
v_mul_f32 v94, s52, v94
v_exp_f32 v93, v93
v_mfma_f32_16x16x32_bf16 v[212:215], v[228:231], v[204:207], v[212:215]
v_cvt_pk_bf16_f32 v200, v88, v89
v_cvt_pk_bf16_f32 v201, v90, v91
v_mfma_f32_32x32x16_bf16 v[72:87], v[136:139], v[104:107], 0
ds_read_b64_tr_b16 v[184:185], v4 offset:36864
ds_read_b64_tr_b16 v[186:187], v4 offset:38912
v_mul_f32 v95, s52, v95
v_add_u32 v1, s54, v1
v_exp_f32 v94, v94
v_mfma_f32_32x32x16_bf16 v[72:87], v[140:143], v[108:111], v[72:87]
ds_read_b64_tr_b16 v[188:189], v4 offset:37120
v_mul_f32 v96, s52, v96
v_cvt_pk_bf16_f32 v202, v92, v93
v_exp_f32 v95, v95
v_mfma_f32_32x32x16_bf16 v[72:87], v[144:147], v[112:115], v[72:87]
ds_read_b64_tr_b16 v[190:191], v4 offset:39168
ds_read_b64_tr_b16 v[192:193], v5 offset:36864
v_mul_f32 v97, s52, v97
v_exp_f32 v96, v96
v_mfma_f32_32x32x16_bf16 v[72:87], v[148:151], v[116:119], v[72:87]
ds_read_b64_tr_b16 v[194:195], v5 offset:38912
v_mul_f32 v98, s52, v98
v_cvt_pk_bf16_f32 v203, v94, v95
v_exp_f32 v97, v97
s_waitcnt lgkmcnt(6)
v_mfma_f32_32x32x16_bf16 v[72:87], v[152:155], v[120:123], v[72:87]
ds_read_b64_tr_b16 v[196:197], v5 offset:37120
v_mul_f32 v99, s52, v99
v_cvt_pk_bf16_f32 v204, v96, v97
v_add_u32 v4, s55, v4
v_exp_f32 v98, v98
v_mfma_f32_32x32x16_bf16 v[72:87], v[156:159], v[124:127], v[72:87]
ds_read_b64_tr_b16 v[198:199], v5 offset:39168
ds_read_b64_tr_b16 v[180:181], v5 offset:33024
v_mul_f32 v100, s52, v100
v_exp_f32 v99, v99
v_mfma_f32_32x32x16_bf16 v[72:87], v[160:163], v[128:131], v[72:87]
v_mul_f32 v101, s52, v101
v_mul_f32 v102, s52, v102
v_add_u32 v5, s55, v5
v_exp_f32 v100, v100
v_mfma_f32_32x32x16_bf16 v[72:87], v[164:167], v[132:135], v[72:87]
v_mul_f32 v103, s52, v103
v_cvt_pk_bf16_f32 v205, v98, v99
v_exp_f32 v101, v101
v_exp_f32 v102, v102
L_mid5:
v_mfma_f32_16x16x32_bf16 v[212:215], v[228:231], v[200:203], v[212:215]
v_cvt_pk_bf16_f32 v206, v100, v101
s_waitcnt lgkmcnt(0)
v_mfma_f32_32x32x16_bf16 v[8:23], v[168:171], v[200:203], v[8:23]
s_barrier
ds_read_b128 v[136:139], v1 offset:0
v_mfma_f32_32x32x16_bf16 v[24:39], v[172:175], v[200:203], v[24:39]
ds_read_b64_tr_b16 v[168:169], v4 offset:0
ds_read_b128 v[140:143], v1 offset:32
v_mul_f32 v72, s52, v72
v_exp_f32 v103, v103
v_mfma_f32_32x32x16_bf16 v[40:55], v[176:179], v[200:203], v[40:55]
ds_read_b64_tr_b16 v[172:173], v4 offset:256
ds_read_b128 v[144:147], v1 offset:256
v_mul_f32 v73, s52, v73
v_cvt_pk_bf16_f32 v207, v102, v103
v_exp_f32 v72, v72
s_sub_u32 s27, s27, 1
v_mfma_f32_32x32x16_bf16 v[56:71], v[180:183], v[200:203], v[56:71]
ds_read_b64_tr_b16 v[176:177], v5 offset:0
ds_read_b128 v[148:151], v1 offset:288
v_mul_f32 v74, s52, v74
v_exp_f32 v73, v73
s_cbranch_scc0 L_body0
v_mfma_f32_32x32x16_bf16 v[8:23], v[184:187], v[204:207], v[8:23]
ds_read_b64_tr_b16 v[170:171], v4 offset:2048
ds_read_b64_tr_b16 v[174:175], v4 offset:2304
ds_read_b64_tr_b16 v[180:181], v5 offset:256
v_cvt_pk_bf16_f32 v200, v72, v73
v_exp_f32 v74, v74
v_mul_f32 v75, s52, v75
v_mul_f32 v76, s52, v76
v_mfma_f32_32x32x16_bf16 v[24:39], v[188:191], v[204:207], v[24:39]
ds_read_b64_tr_b16 v[178:179], v5 offset:2048
ds_read_b64_tr_b16 v[182:183], v5 offset:2304
v_exp_f32 v75, v75
v_mul_f32 v77, s52, v77
v_exp_f32 v76, v76
v_mul_f32 v78, s52, v78
v_mfma_f32_32x32x16_bf16 v[40:55], v[192:195], v[204:207], v[40:55]
ds_read_b64_tr_b16 v[184:185], v4 offset:4096
ds_read_b64_tr_b16 v[186:187], v4 offset:6144
v_exp_f32 v77, v77
v_mul_f32 v79, s52, v79
v_cvt_pk_bf16_f32 v201, v74, v75
v_exp_f32 v78, v78
s_waitcnt lgkmcnt(7)
v_mfma_f32_32x32x16_bf16 v[56:71], v[196:199], v[204:207], v[56:71]
v_exp_f32 v79, v79
v_cvt_pk_bf16_f32 v202, v76, v77
v_mul_f32 v80, s52, v80
v_mul_f32 v81, s52, v81
v_cvt_pk_bf16_f32 v203, v78, v79
v_mfma_f32_16x16x32_bf16 v[212:215], v[228:231], v[204:207], v[212:215]
ds_read_b64_tr_b16 v[188:189], v4 offset:4352
ds_read_b64_tr_b16 v[190:191], v4 offset:6400
s_waitcnt lgkmcnt(4)
v_mfma_f32_32x32x16_bf16 v[8:23], v[168:171], v[200:203], v[8:23]
ds_read_b64_tr_b16 v[192:193], v5 offset:4096
ds_read_b64_tr_b16 v[194:195], v5 offset:6144
v_exp_f32 v80, v80
v_mul_f32 v82, s52, v82
v_exp_f32 v81, v81
v_mul_f32 v83, s52, v83
v_mfma_f32_32x32x16_bf16 v[24:39], v[172:175], v[200:203], v[24:39]
ds_read_b64_tr_b16 v[196:197], v5 offset:4352
ds_read_b64_tr_b16 v[198:199], v5 offset:6400
v_exp_f32 v82, v82
v_mul_f32 v84, s52, v84
v_exp_f32 v83, v83
v_mul_f32 v85, s52, v85
v_mfma_f32_32x32x16_bf16 v[40:55], v[176:179], v[200:203], v[40:55]
s_cmp_lg_u32 s81, 0
v_exp_f32 v84, v84
s_cbranch_scc1 L_tb7
L_tc7:
v_mul_f32 v86, s52, v86
v_exp_f32 v85, v85
v_mul_f32 v87, s52, v87
v_cvt_pk_bf16_f32 v204, v80, v81
v_mfma_f32_32x32x16_bf16 v[56:71], v[180:183], v[200:203], v[56:71]
v_exp_f32 v86, v86
v_cvt_pk_bf16_f32 v205, v82, v83
v_exp_f32 v87, v87
v_cvt_pk_bf16_f32 v206, v84, v85
v_mfma_f32_16x16x32_bf16 v[212:215], v[228:231], v[200:203], v[212:215]
v_cvt_pk_bf16_f32 v207, v86, v87
s_cmp_lg_u32 s59, 0
s_waitcnt lgkmcnt(0)
v_mfma_f32_16x16x32_bf16 v[212:215], v[228:231], v[204:207], v[212:215]
v_mfma_f32_32x32x16_bf16 v[8:23], v[184:187], v[204:207], v[8:23]
s_cbranch_scc1 L_comb
v_mfma_f32_32x32x16_bf16 v[24:39], v[188:191], v[204:207], v[24:39]
v_subrev_u32 v217, 0x33800000, v212
v_rcp_f32 v216, v212
v_cmp_lt_u32 vcc, 0x18000000, v217
v_mfma_f32_32x32x16_bf16 v[40:55], v[192:195], v[204:207], v[40:55]
v_mul_f32 v8, v216, v8
v_mul_f32 v9, v216, v9
v_mul_f32 v10, v216, v10
v_mul_f32 v11, v216, v11
v_mul_f32 v12, v216, v12
v_mul_f32 v13, v216, v13
v_mul_f32 v14, v216, v14
v_mfma_f32_32x32x16_bf16 v[56:71], v[196:199], v[204:207], v[56:71]
v_mul_f32 v15, v216, v15
v_cvt_pk_bf16_f32 v136, v8, v9
v_cvt_pk_bf16_f32 v137, v10, v11
v_cvt_pk_bf16_f32 v138, v12, v13
v_cvt_pk_bf16_f32 v139, v14, v15
ds_write_b128 v6, v[136:139] offset:0
v_mul_f32 v16, v216, v16
v_mul_f32 v17, v216, v17
v_mul_f32 v18, v216, v18
v_mul_f32 v19, v216, v19
v_mul_f32 v20, v216, v20
v_mul_f32 v21, v216, v21
v_mul_f32 v22, v216, v22
v_mul_f32 v23, v216, v23
v_cvt_pk_bf16_f32 v140, v16, v17
v_cvt_pk_bf16_f32 v141, v18, v19
v_cvt_pk_bf16_f32 v142, v20, v21
v_cvt_pk_bf16_f32 v143, v22, v23
ds_write_b128 v6, v[140:143] offset:16
ds_read_b128 v[168:171], v7 offset:0
ds_read_b128 v[172:175], v7 offset:4352
L_epi1:
v_pk_mul_f32 v[24:25], v[24:25], v[216:217] op_sel_hi:[1,0]
v_pk_mul_f32 v[26:27], v[26:27], v[216:217] op_sel_hi:[1,0]
v_pk_mul_f32 v[28:29], v[28:29], v[216:217] op_sel_hi:[1,0]
v_pk_mul_f32 v[30:31], v[30:31], v[216:217] op_sel_hi:[1,0]
v_cvt_pk_bf16_f32 v144, v24, v25
v_cvt_pk_bf16_f32 v145, v26, v27
v_cvt_pk_bf16_f32 v146, v28, v29
v_cvt_pk_bf16_f32 v147, v30, v31
ds_write_b128 v6, v[144:147] offset:64
s_cbranch_vccnz L_fb
s_waitcnt lgkmcnt(2)
buffer_store_dwordx4 v[168:171], v208, s[44:47], s92 offen offset:0 nt
v_pk_mul_f32 v[32:33], v[32:33], v[216:217] op_sel_hi:[1,0]
v_pk_mul_f32 v[34:35], v[34:35], v[216:217] op_sel_hi:[1,0]
v_pk_mul_f32 v[36:37], v[36:37], v[216:217] op_sel_hi:[1,0]
v_pk_mul_f32 v[38:39], v[38:39], v[216:217] op_sel_hi:[1,0]
v_cvt_pk_bf16_f32 v148, v32, v33
v_cvt_pk_bf16_f32 v149, v34, v35
v_cvt_pk_bf16_f32 v150, v36, v37
v_cvt_pk_bf16_f32 v151, v38, v39
ds_write_b128 v6, v[148:151] offset:80
ds_read_b128 v[176:179], v7 offset:64
ds_read_b128 v[180:183], v7 offset:4416
s_waitcnt lgkmcnt(4)
buffer_store_dwordx4 v[172:175], v208, s[44:47], s93 offen offset:0 nt
v_pk_mul_f32 v[40:41], v[40:41], v[216:217] op_sel_hi:[1,0]
v_pk_mul_f32 v[42:43], v[42:43], v[216:217] op_sel_hi:[1,0]
v_pk_mul_f32 v[44:45], v[44:45], v[216:217] op_sel_hi:[1,0]
v_pk_mul_f32 v[46:47], v[46:47], v[216:217] op_sel_hi:[1,0]
v_cvt_pk_bf16_f32 v152, v40, v41
v_cvt_pk_bf16_f32 v153, v42, v43
v_cvt_pk_bf16_f32 v154, v44, v45
v_cvt_pk_bf16_f32 v155, v46, v47
ds_write_b128 v6, v[152:155] offset:128
s_waitcnt lgkmcnt(2)
buffer_store_dwordx4 v[176:179], v208, s[44:47], s92 offen offset:64 nt
v_pk_mul_f32 v[48:49], v[48:49], v[216:217] op_sel_hi:[1,0]
v_pk_mul_f32 v[50:51], v[50:51], v[216:217] op_sel_hi:[1,0]
v_pk_mul_f32 v[52:53], v[52:53], v[216:217] op_sel_hi:[1,0]
v_pk_mul_f32 v[54:55], v[54:55], v[216:217] op_sel_hi:[1,0]
v_cvt_pk_bf16_f32 v156, v48, v49
v_cvt_pk_bf16_f32 v157, v50, v51
v_cvt_pk_bf16_f32 v158, v52, v53
v_cvt_pk_bf16_f32 v159, v54, v55
ds_write_b128 v6, v[156:159] offset:144
ds_read_b128 v[184:187], v7 offset:128
ds_read_b128 v[188:191], v7 offset:4480
s_waitcnt lgkmcnt(4)
buffer_store_dwordx4 v[180:183], v208, s[44:47], s93 offen offset:64 nt
v_pk_mul_f32 v[56:57], v[56:57], v[216:217] op_sel_hi:[1,0]
v_pk_mul_f32 v[58:59], v[58:59], v[216:217] op_sel_hi:[1,0]
v_pk_mul_f32 v[60:61], v[60:61], v[216:217] op_sel_hi:[1,0]
v_pk_mul_f32 v[62:63], v[62:63], v[216:217] op_sel_hi:[1,0]
v_cvt_pk_bf16_f32 v160, v56, v57
v_cvt_pk_bf16_f32 v161, v58, v59
v_cvt_pk_bf16_f32 v162, v60, v61
v_cvt_pk_bf16_f32 v163, v62, v63
ds_write_b128 v6, v[160:163] offset:192
s_waitcnt lgkmcnt(2)
buffer_store_dwordx4 v[184:187], v208, s[44:47], s94 offen offset:0 nt
v_pk_mul_f32 v[64:65], v[64:65], v[216:217] op_sel_hi:[1,0]
v_pk_mul_f32 v[66:67], v[66:67], v[216:217] op_sel_hi:[1,0]
v_pk_mul_f32 v[68:69], v[68:69], v[216:217] op_sel_hi:[1,0]
v_pk_mul_f32 v[70:71], v[70:71], v[216:217] op_sel_hi:[1,0]
v_cvt_pk_bf16_f32 v164, v64, v65
v_cvt_pk_bf16_f32 v165, v66, v67
v_cvt_pk_bf16_f32 v166, v68, v69
v_cvt_pk_bf16_f32 v167, v70, v71
ds_write_b128 v6, v[164:167] offset:208
ds_read_b128 v[192:195], v7 offset:192
ds_read_b128 v[196:199], v7 offset:4544
s_waitcnt lgkmcnt(4)
buffer_store_dwordx4 v[188:191], v208, s[44:47], s95 offen offset:0 nt
s_waitcnt lgkmcnt(1)
buffer_store_dwordx4 v[192:195], v208, s[44:47], s94 offen offset:64 nt
s_waitcnt lgkmcnt(0)
buffer_store_dwordx4 v[196:199], v208, s[44:47], s95 offen offset:64 nt
L_fin:
L_end:
s_endpgm
L_comb:
v_mfma_f32_32x32x16_bf16 v[24:39], v[188:191], v[204:207], v[24:39]
ds_write_b32 v224, v212 offset:8192
v_mfma_f32_32x32x16_bf16 v[40:55], v[192:195], v[204:207], v[40:55]
ds_write_b128 v220, v[8:11] offset:0
ds_write_b128 v220, v[12:15] offset:1024
v_mfma_f32_32x32x16_bf16 v[56:71], v[196:199], v[204:207], v[56:71]
ds_write_b128 v220, v[16:19] offset:2048
ds_write_b128 v220, v[20:23] offset:3072
ds_write_b128 v220, v[24:27] offset:4096
ds_write_b128 v220, v[28:31] offset:5120
ds_write_b128 v220, v[32:35] offset:6144
ds_write_b128 v220, v[36:39] offset:7168
s_waitcnt lgkmcnt(0)
s_barrier
ds_read_b32 v218, v225 offset:8192
ds_read_b128 v[8:11], v2 offset:0
ds_read_b128 v[12:15], v2 offset:1024
ds_read_b128 v[16:19], v2 offset:2048
ds_read_b128 v[20:23], v2 offset:3072
ds_read_b128 v[24:27], v2 offset:4096
ds_read_b128 v[28:31], v2 offset:5120
ds_read_b128 v[32:35], v2 offset:6144
ds_read_b128 v[36:39], v2 offset:7168
s_waitcnt lgkmcnt(8)
v_add_f32 v212, v212, v218
v_subrev_u32 v217, 0x33800000, v212
v_rcp_f32 v216, v212
v_cmp_lt_u32 vcc, 0x18000000, v217
s_waitcnt lgkmcnt(7)
v_pk_add_f32 v[40:41], v[40:41], v[8:9]
v_pk_add_f32 v[42:43], v[42:43], v[10:11]
s_waitcnt lgkmcnt(6)
v_pk_add_f32 v[44:45], v[44:45], v[12:13]
v_pk_add_f32 v[46:47], v[46:47], v[14:15]
s_waitcnt lgkmcnt(5)
v_pk_add_f32 v[48:49], v[48:49], v[16:17]
v_pk_add_f32 v[50:51], v[50:51], v[18:19]
s_waitcnt lgkmcnt(4)
v_pk_add_f32 v[52:53], v[52:53], v[20:21]
v_pk_add_f32 v[54:55], v[54:55], v[22:23]
s_waitcnt lgkmcnt(3)
v_pk_add_f32 v[56:57], v[56:57], v[24:25]
v_pk_add_f32 v[58:59], v[58:59], v[26:27]
s_waitcnt lgkmcnt(2)
v_pk_add_f32 v[60:61], v[60:61], v[28:29]
v_pk_add_f32 v[62:63], v[62:63], v[30:31]
s_waitcnt lgkmcnt(1)
v_pk_add_f32 v[64:65], v[64:65], v[32:33]
v_pk_add_f32 v[66:67], v[66:67], v[34:35]
s_waitcnt lgkmcnt(0)
v_pk_add_f32 v[68:69], v[68:69], v[36:37]
v_pk_add_f32 v[70:71], v[70:71], v[38:39]
s_cbranch_vccnz L_fbS
v_pk_mul_f32 v[40:41], v[40:41], v[216:217] op_sel_hi:[1,0]
v_pk_mul_f32 v[42:43], v[42:43], v[216:217] op_sel_hi:[1,0]
v_pk_mul_f32 v[44:45], v[44:45], v[216:217] op_sel_hi:[1,0]
v_pk_mul_f32 v[46:47], v[46:47], v[216:217] op_sel_hi:[1,0]
v_cvt_pk_bf16_f32 v152, v40, v41
v_cvt_pk_bf16_f32 v153, v42, v43
v_cvt_pk_bf16_f32 v154, v44, v45
v_cvt_pk_bf16_f32 v155, v46, v47
ds_write_b128 v6, v[152:155] offset:128
v_pk_mul_f32 v[48:49], v[48:49], v[216:217] op_sel_hi:[1,0]
v_pk_mul_f32 v[50:51], v[50:51], v[216:217] op_sel_hi:[1,0]
v_pk_mul_f32 v[52:53], v[52:53], v[216:217] op_sel_hi:[1,0]
v_pk_mul_f32 v[54:55], v[54:55], v[216:217] op_sel_hi:[1,0]
v_cvt_pk_bf16_f32 v156, v48, v49
v_cvt_pk_bf16_f32 v157, v50, v51
v_cvt_pk_bf16_f32 v158, v52, v53
v_cvt_pk_bf16_f32 v159, v54, v55
ds_write_b128 v6, v[156:159] offset:144
ds_read_b128 v[184:187], v7 offset:128
ds_read_b128 v[188:191], v7 offset:4480
v_pk_mul_f32 v[56:57], v[56:57], v[216:217] op_sel_hi:[1,0]
v_pk_mul_f32 v[58:59], v[58:59], v[216:217] op_sel_hi:[1,0]
v_pk_mul_f32 v[60:61], v[60:61], v[216:217] op_sel_hi:[1,0]
v_pk_mul_f32 v[62:63], v[62:63], v[216:217] op_sel_hi:[1,0]
v_cvt_pk_bf16_f32 v160, v56, v57
v_cvt_pk_bf16_f32 v161, v58, v59
v_cvt_pk_bf16_f32 v162, v60, v61
v_cvt_pk_bf16_f32 v163, v62, v63
ds_write_b128 v6, v[160:163] offset:192
s_waitcnt lgkmcnt(2)
buffer_store_dwordx4 v[184:187], v208, s[44:47], s94 offen offset:0 nt
v_pk_mul_f32 v[64:65], v[64:65], v[216:217] op_sel_hi:[1,0]
v_pk_mul_f32 v[66:67], v[66:67], v[216:217] op_sel_hi:[1,0]
v_pk_mul_f32 v[68:69], v[68:69], v[216:217] op_sel_hi:[1,0]
v_pk_mul_f32 v[70:71], v[70:71], v[216:217] op_sel_hi:[1,0]
v_cvt_pk_bf16_f32 v164, v64, v65
v_cvt_pk_bf16_f32 v165, v66, v67
v_cvt_pk_bf16_f32 v166, v68, v69
v_cvt_pk_bf16_f32 v167, v70, v71
ds_write_b128 v6, v[164:167] offset:208
ds_read_b128 v[192:195], v7 offset:192
ds_read_b128 v[196:199], v7 offset:4544
s_waitcnt lgkmcnt(4)
buffer_store_dwordx4 v[188:191], v208, s[44:47], s95 offen offset:0 nt
s_waitcnt lgkmcnt(1)
buffer_store_dwordx4 v[192:195], v208, s[44:47], s94 offen offset:64 nt
s_waitcnt lgkmcnt(0)
buffer_store_dwordx4 v[196:199], v208, s[44:47], s95 offen offset:64 nt
s_endpgm
L_tb7:
s_barrier
s_branch L_tc7
L_fbS:
s_barrier
L_fb:
s_waitcnt lgkmcnt(0)
s_lshl_b32 s24, s56, 13
s_add_u32 s24, s24, 83968
s_sub_u32 s24, s48, s24
s_mov_b32 s55, 0
s_mul_i32 s57, s56, 8320
s_add_u32 s57, s57, 16640
s_sub_u32 s57, s48, s57
s_mov_b32 s56, s19
s_nop 7
v_mov_b32 v8, 0
v_mov_b32 v9, 0
v_mov_b32 v10, 0
v_mov_b32 v11, 0
v_mov_b32 v12, 0
v_mov_b32 v13, 0
v_mov_b32 v14, 0
v_mov_b32 v15, 0
v_mov_b32 v16, 0
v_mov_b32 v17, 0
v_mov_b32 v18, 0
v_mov_b32 v19, 0
v_mov_b32 v20, 0
v_mov_b32 v21, 0
v_mov_b32 v22, 0
v_mov_b32 v23, 0
v_mov_b32 v24, 0
v_mov_b32 v25, 0
v_mov_b32 v26, 0
v_mov_b32 v27, 0
v_mov_b32 v28, 0
v_mov_b32 v29, 0
v_mov_b32 v30, 0
v_mov_b32 v31, 0
v_mov_b32 v32, 0
v_mov_b32 v33, 0
v_mov_b32 v34, 0
v_mov_b32 v35, 0
v_mov_b32 v36, 0
v_mov_b32 v37, 0
v_mov_b32 v38, 0
v_mov_b32 v39, 0
v_mov_b32 v40, 0
v_mov_b32 v41, 0
v_mov_b32 v42, 0
v_mov_b32 v43, 0
v_mov_b32 v44, 0
v_mov_b32 v45, 0
v_mov_b32 v46, 0
v_mov_b32 v47, 0
v_mov_b32 v48, 0
v_mov_b32 v49, 0
v_mov_b32 v50, 0
v_mov_b32 v51, 0
v_mov_b32 v52, 0
v_mov_b32 v53, 0
v_mov_b32 v54, 0
v_mov_b32 v55, 0
v_mov_b32 v56, 0
v_mov_b32 v57, 0
v_mov_b32 v58, 0
v_mov_b32 v59, 0
v_mov_b32 v60, 0
v_mov_b32 v61, 0
v_mov_b32 v62, 0
v_mov_b32 v63, 0
v_mov_b32 v64, 0
v_mov_b32 v65, 0
v_mov_b32 v66, 0
v_mov_b32 v67, 0
v_mov_b32 v68, 0
v_mov_b32 v69, 0
v_mov_b32 v70, 0
v_mov_b32 v71, 0
v_mov_b32 v212, 0
v_mov_b32 v219, 0xff800000
v_lshrrev_b32 v217, 5, v0
v_add_u32 v1, s57, v1
v_add_u32 v4, s24, v4
v_add_u32 v5, s24, v5
s_sub_u32 s24, s48, s58
v_add_u32 v6, s24, v6
v_add_u32 v7, s24, v7
L_fb_loop:
s_mov_b32 s51, s55
s_mov_b32 s57, s48
s_mov_b32 m0, s57
s_add_u32 s57, s57, 1040
buffer_load_dwordx4 v3, s[36:39], s51 offen lds
s_add_u32 s51, s51, 16384
s_mov_b32 m0, s57
s_add_u32 s57, s57, 1040
buffer_load_dwordx4 v3, s[36:39], s51 offen lds
s_add_u32 s51, s51, 16384
s_mov_b32 m0, s57
s_add_u32 s57, s57, 1040
buffer_load_dwordx4 v3, s[36:39], s51 offen lds
s_add_u32 s51, s51, 16384
s_mov_b32 m0, s57
s_add_u32 s57, s57, 1040
buffer_load_dwordx4 v3, s[36:39], s51 offen lds
s_add_u32 s51, s51, 16384
s_mov_b32 m0, s57
s_add_u32 s57, s57, 1040
buffer_load_dwordx4 v3, s[36:39], s51 offen lds
s_add_u32 s51, s51, 16384
s_mov_b32 m0, s57
s_add_u32 s57, s57, 1040
buffer_load_dwordx4 v3, s[36:39], s51 offen lds
s_add_u32 s51, s51, 16384
s_mov_b32 m0, s57
s_add_u32 s57, s57, 1040
buffer_load_dwordx4 v3, s[36:39], s51 offen lds
s_add_u32 s51, s51, 16384
s_mov_b32 m0, s57
s_add_u32 s57, s57, 1040
buffer_load_dwordx4 v3, s[36:39], s51 offen lds
s_add_u32 s51, s51, 16384
v_lshlrev_b32 v218, 2, v217
v_sub_u32 v218, s56, v218
v_mov_b32 v216, 0xff800000
v_cmp_lt_i32 vcc, 0, v218
s_nop 1
v_cndmask_b32 v72, v216, 0, vcc
v_cmp_lt_i32 vcc, 1, v218
s_nop 1
v_cndmask_b32 v73, v216, 0, vcc
v_cmp_lt_i32 vcc, 2, v218
s_nop 1
v_cndmask_b32 v74, v216, 0, vcc
v_cmp_lt_i32 vcc, 3, v218
s_nop 1
v_cndmask_b32 v75, v216, 0, vcc
v_cmp_lt_i32 vcc, 8, v218
s_nop 1
v_cndmask_b32 v76, v216, 0, vcc
v_cmp_lt_i32 vcc, 9, v218
s_nop 1
v_cndmask_b32 v77, v216, 0, vcc
v_cmp_lt_i32 vcc, 10, v218
s_nop 1
v_cndmask_b32 v78, v216, 0, vcc
v_cmp_lt_i32 vcc, 11, v218
s_nop 1
v_cndmask_b32 v79, v216, 0, vcc
v_cmp_lt_i32 vcc, 16, v218
s_nop 1
v_cndmask_b32 v80, v216, 0, vcc
v_cmp_lt_i32 vcc, 17, v218
s_nop 1
v_cndmask_b32 v81, v216, 0, vcc
v_cmp_lt_i32 vcc, 18, v218
s_nop 1
v_cndmask_b32 v82, v216, 0, vcc
v_cmp_lt_i32 vcc, 19, v218
s_nop 1
v_cndmask_b32 v83, v216, 0, vcc
v_cmp_lt_i32 vcc, 24, v218
s_nop 1
v_cndmask_b32 v84, v216, 0, vcc
v_cmp_lt_i32 vcc, 25, v218
s_nop 1
v_cndmask_b32 v85, v216, 0, vcc
v_cmp_lt_i32 vcc, 26, v218
s_nop 1
v_cndmask_b32 v86, v216, 0, vcc
v_cmp_lt_i32 vcc, 27, v218
s_nop 1
v_cndmask_b32 v87, v216, 0, vcc
s_waitcnt vmcnt(0)
ds_read_b128 v[136:139], v1 offset:0
ds_read_b128 v[140:143], v1 offset:32
ds_read_b128 v[144:147], v1 offset:256
ds_read_b128 v[148:151], v1 offset:288
ds_read_b128 v[152:155], v1 offset:512
ds_read_b128 v[156:159], v1 offset:544
ds_read_b128 v[160:163], v1 offset:768
ds_read_b128 v[164:167], v1 offset:800
s_waitcnt lgkmcnt(0)
s_mov_b32 s51, s55
s_mov_b32 s57, s48
s_mov_b32 m0, s57
s_add_u32 s57, s57, 1024
buffer_load_dwordx4 v3, s[40:43], s51 offen lds
s_add_u32 s51, s51, 16384
s_mov_b32 m0, s57
s_add_u32 s57, s57, 1024
buffer_load_dwordx4 v3, s[40:43], s51 offen lds
s_add_u32 s51, s51, 16384
s_mov_b32 m0, s57
s_add_u32 s57, s57, 1024
buffer_load_dwordx4 v3, s[40:43], s51 offen lds
s_add_u32 s51, s51, 16384
s_mov_b32 m0, s57
s_add_u32 s57, s57, 1024
buffer_load_dwordx4 v3, s[40:43], s51 offen lds
s_add_u32 s51, s51, 16384
s_mov_b32 m0, s57
s_add_u32 s57, s57, 1024
buffer_load_dwordx4 v3, s[40:43], s51 offen lds
s_add_u32 s51, s51, 16384
s_mov_b32 m0, s57
s_add_u32 s57, s57, 1024
buffer_load_dwordx4 v3, s[40:43], s51 offen lds
s_add_u32 s51, s51, 16384
s_mov_b32 m0, s57
s_add_u32 s57, s57, 1024
buffer_load_dwordx4 v3, s[40:43], s51 offen lds
s_add_u32 s51, s51, 16384
s_mov_b32 m0, s57
s_add_u32 s57, s57, 1024
buffer_load_dwordx4 v3, s[40:43], s51 offen lds
s_add_u32 s51, s51, 16384
v_mfma_f32_32x32x16_bf16 v[72:87], v[136:139], v[104:107], v[72:87]
v_mfma_f32_32x32x16_bf16 v[72:87], v[140:143], v[108:111], v[72:87]
v_mfma_f32_32x32x16_bf16 v[72:87], v[144:147], v[112:115], v[72:87]
v_mfma_f32_32x32x16_bf16 v[72:87], v[148:151], v[116:119], v[72:87]
v_mfma_f32_32x32x16_bf16 v[72:87], v[152:155], v[120:123], v[72:87]
v_mfma_f32_32x32x16_bf16 v[72:87], v[156:159], v[124:127], v[72:87]
v_mfma_f32_32x32x16_bf16 v[72:87], v[160:163], v[128:131], v[72:87]
v_mfma_f32_32x32x16_bf16 v[72:87], v[164:167], v[132:135], v[72:87]
s_nop 7
s_nop 3
v_pk_mul_f32 v[72:73], v[72:73], s[52:53]
v_pk_mul_f32 v[74:75], v[74:75], s[52:53]
v_pk_mul_f32 v[76:77], v[76:77], s[52:53]
v_pk_mul_f32 v[78:79], v[78:79], s[52:53]
v_pk_mul_f32 v[80:81], v[80:81], s[52:53]
v_pk_mul_f32 v[82:83], v[82:83], s[52:53]
v_pk_mul_f32 v[84:85], v[84:85], s[52:53]
v_pk_mul_f32 v[86:87], v[86:87], s[52:53]
v_max3_f32 v216, v72, v73, v219
v_max3_f32 v216, v74, v75, v216
v_max3_f32 v216, v76, v77, v216
v_max3_f32 v216, v78, v79, v216
v_max3_f32 v216, v80, v81, v216
v_max3_f32 v216, v82, v83, v216
v_max3_f32 v216, v84, v85, v216
v_max3_f32 v216, v86, v87, v216
v_mov_b32 v218, v216
s_nop 1
v_permlane32_swap_b32 v218, v216
v_max_f32 v216, v218, v216
v_sub_f32 v218, v219, v216
v_exp_f32 v218, v218
v_mov_b32 v219, v216
v_mul_f32 v212, v212, v218
v_mul_f32 v8, v8, v218
v_mul_f32 v9, v9, v218
v_mul_f32 v10, v10, v218
v_mul_f32 v11, v11, v218
v_mul_f32 v12, v12, v218
v_mul_f32 v13, v13, v218
v_mul_f32 v14, v14, v218
v_mul_f32 v15, v15, v218
v_mul_f32 v16, v16, v218
v_mul_f32 v17, v17, v218
v_mul_f32 v18, v18, v218
v_mul_f32 v19, v19, v218
v_mul_f32 v20, v20, v218
v_mul_f32 v21, v21, v218
v_mul_f32 v22, v22, v218
v_mul_f32 v23, v23, v218
v_mul_f32 v24, v24, v218
v_mul_f32 v25, v25, v218
v_mul_f32 v26, v26, v218
v_mul_f32 v27, v27, v218
v_mul_f32 v28, v28, v218
v_mul_f32 v29, v29, v218
v_mul_f32 v30, v30, v218
v_mul_f32 v31, v31, v218
v_mul_f32 v32, v32, v218
v_mul_f32 v33, v33, v218
v_mul_f32 v34, v34, v218
v_mul_f32 v35, v35, v218
v_mul_f32 v36, v36, v218
v_mul_f32 v37, v37, v218
v_mul_f32 v38, v38, v218
v_mul_f32 v39, v39, v218
v_mul_f32 v40, v40, v218
v_mul_f32 v41, v41, v218
v_mul_f32 v42, v42, v218
v_mul_f32 v43, v43, v218
v_mul_f32 v44, v44, v218
v_mul_f32 v45, v45, v218
v_mul_f32 v46, v46, v218
v_mul_f32 v47, v47, v218
v_mul_f32 v48, v48, v218
v_mul_f32 v49, v49, v218
v_mul_f32 v50, v50, v218
v_mul_f32 v51, v51, v218
v_mul_f32 v52, v52, v218
v_mul_f32 v53, v53, v218
v_mul_f32 v54, v54, v218
v_mul_f32 v55, v55, v218
v_mul_f32 v56, v56, v218
v_mul_f32 v57, v57, v218
v_mul_f32 v58, v58, v218
v_mul_f32 v59, v59, v218
v_mul_f32 v60, v60, v218
v_mul_f32 v61, v61, v218
v_mul_f32 v62, v62, v218
v_mul_f32 v63, v63, v218
v_mul_f32 v64, v64, v218
v_mul_f32 v65, v65, v218
v_mul_f32 v66, v66, v218
v_mul_f32 v67, v67, v218
v_mul_f32 v68, v68, v218
v_mul_f32 v69, v69, v218
v_mul_f32 v70, v70, v218
v_mul_f32 v71, v71, v218
v_sub_f32 v72, v72, v219
v_sub_f32 v73, v73, v219
v_sub_f32 v74, v74, v219
v_sub_f32 v75, v75, v219
v_sub_f32 v76, v76, v219
v_sub_f32 v77, v77, v219
v_sub_f32 v78, v78, v219
v_sub_f32 v79, v79, v219
v_sub_f32 v80, v80, v219
v_sub_f32 v81, v81, v219
v_sub_f32 v82, v82, v219
v_sub_f32 v83, v83, v219
v_sub_f32 v84, v84, v219
v_sub_f32 v85, v85, v219
v_sub_f32 v86, v86, v219
v_sub_f32 v87, v87, v219
v_exp_f32 v72, v72
v_exp_f32 v73, v73
v_exp_f32 v74, v74
v_exp_f32 v75, v75
v_exp_f32 v76, v76
v_exp_f32 v77, v77
v_exp_f32 v78, v78
v_exp_f32 v79, v79
v_exp_f32 v80, v80
v_exp_f32 v81, v81
v_exp_f32 v82, v82
v_exp_f32 v83, v83
v_exp_f32 v84, v84
v_exp_f32 v85, v85
v_exp_f32 v86, v86
v_exp_f32 v87, v87
s_nop 0
v_add_f32 v212, v212, v72
v_add_f32 v212, v212, v73
v_add_f32 v212, v212, v74
v_add_f32 v212, v212, v75
v_add_f32 v212, v212, v76
v_add_f32 v212, v212, v77
v_add_f32 v212, v212, v78
v_add_f32 v212, v212, v79
v_add_f32 v212, v212, v80
v_add_f32 v212, v212, v81
v_add_f32 v212, v212, v82
v_add_f32 v212, v212, v83
v_add_f32 v212, v212, v84
v_add_f32 v212, v212, v85
v_add_f32 v212, v212, v86
v_add_f32 v212, v212, v87
v_cvt_pk_bf16_f32 v200, v72, v73
v_cvt_pk_bf16_f32 v201, v74, v75
v_cvt_pk_bf16_f32 v202, v76, v77
v_cvt_pk_bf16_f32 v203, v78, v79
v_cvt_pk_bf16_f32 v204, v80, v81
v_cvt_pk_bf16_f32 v205, v82, v83
v_cvt_pk_bf16_f32 v206, v84, v85
v_cvt_pk_bf16_f32 v207, v86, v87
s_waitcnt vmcnt(0)
ds_read_b64_tr_b16 v[168:169], v4 offset:0
ds_read_b64_tr_b16 v[170:171], v4 offset:2048
ds_read_b64_tr_b16 v[172:173], v4 offset:256
ds_read_b64_tr_b16 v[174:175], v4 offset:2304
ds_read_b64_tr_b16 v[176:177], v5 offset:0
ds_read_b64_tr_b16 v[178:179], v5 offset:2048
ds_read_b64_tr_b16 v[180:181], v5 offset:256
ds_read_b64_tr_b16 v[182:183], v5 offset:2304
ds_read_b64_tr_b16 v[184:185], v4 offset:4096
ds_read_b64_tr_b16 v[186:187], v4 offset:6144
ds_read_b64_tr_b16 v[188:189], v4 offset:4352
ds_read_b64_tr_b16 v[190:191], v4 offset:6400
ds_read_b64_tr_b16 v[192:193], v5 offset:4096
ds_read_b64_tr_b16 v[194:195], v5 offset:6144
ds_read_b64_tr_b16 v[196:197], v5 offset:4352
s_waitcnt lgkmcnt(0)
ds_read_b64_tr_b16 v[198:199], v5 offset:6400
s_waitcnt lgkmcnt(0)
v_mfma_f32_32x32x16_bf16 v[8:23], v[168:171], v[200:203], v[8:23]
v_mfma_f32_32x32x16_bf16 v[24:39], v[172:175], v[200:203], v[24:39]
v_mfma_f32_32x32x16_bf16 v[40:55], v[176:179], v[200:203], v[40:55]
v_mfma_f32_32x32x16_bf16 v[56:71], v[180:183], v[200:203], v[56:71]
v_mfma_f32_32x32x16_bf16 v[8:23], v[184:187], v[204:207], v[8:23]
v_mfma_f32_32x32x16_bf16 v[24:39], v[188:191], v[204:207], v[24:39]
v_mfma_f32_32x32x16_bf16 v[40:55], v[192:195], v[204:207], v[40:55]
v_mfma_f32_32x32x16_bf16 v[56:71], v[196:199], v[204:207], v[56:71]
s_add_u32 s55, s55, 0x20000
s_sub_u32 s56, s56, 32
s_cmp_gt_i32 s56, 0
s_cbranch_scc1 L_fb_loop
v_mov_b32 v216, v212
s_nop 1
v_permlane32_swap_b32 v216, v212
s_nop 7
v_add_f32 v212, v212, v216
v_rcp_f32 v216, v212
s_nop 0
v_pk_mul_f32 v[8:9], v[8:9], v[216:217] op_sel_hi:[1,0]
v_pk_mul_f32 v[10:11], v[10:11], v[216:217] op_sel_hi:[1,0]
v_pk_mul_f32 v[12:13], v[12:13], v[216:217] op_sel_hi:[1,0]
v_pk_mul_f32 v[14:15], v[14:15], v[216:217] op_sel_hi:[1,0]
v_cvt_pk_bf16_f32 v136, v8, v9
v_cvt_pk_bf16_f32 v137, v10, v11
v_cvt_pk_bf16_f32 v138, v12, v13
v_cvt_pk_bf16_f32 v139, v14, v15
ds_write_b128 v6, v[136:139] offset:0
v_pk_mul_f32 v[16:17], v[16:17], v[216:217] op_sel_hi:[1,0]
v_pk_mul_f32 v[18:19], v[18:19], v[216:217] op_sel_hi:[1,0]
v_pk_mul_f32 v[20:21], v[20:21], v[216:217] op_sel_hi:[1,0]
v_pk_mul_f32 v[22:23], v[22:23], v[216:217] op_sel_hi:[1,0]
v_cvt_pk_bf16_f32 v140, v16, v17
v_cvt_pk_bf16_f32 v141, v18, v19
v_cvt_pk_bf16_f32 v142, v20, v21
v_cvt_pk_bf16_f32 v143, v22, v23
ds_write_b128 v6, v[140:143] offset:16
ds_read_b128 v[168:171], v7 offset:0
ds_read_b128 v[172:175], v7 offset:4352
s_mov_b64 vcc, 0
s_branch L_epi1
.section .rodata,"a"
.p2align 6
.amdhsa_kernel standalone__ragged_sequences_packed_sequences__ragged_kernel
  .amdhsa_next_free_vgpr 236
  .amdhsa_next_free_sgpr 100
  .amdhsa_accum_offset 236
  .amdhsa_group_segment_fixed_size 0
  .amdhsa_kernarg_size 56
  .amdhsa_user_sgpr_count 2
  .amdhsa_user_sgpr_kernarg_segment_ptr 1
  .amdhsa_system_sgpr_workgroup_id_x 1
.end_amdhsa_kernel
```
